```python
import torch

def _softmax(x, axis=-1):
    return torch.softmax(x, dim=axis)
def _gelu(x):
    return torch.nn.functional.gelu(x, approximate="tanh")
def _silu(x):
    return torch.nn.functional.silu(x)
def _sigmoid(x):
    return torch.sigmoid(x)
def _layernorm(x, axis=-1, eps=1e-5):
    m = x.mean(dim=axis, keepdim=True)
    v = x.var(dim=axis, keepdim=True, unbiased=False)
    return (x - m) / torch.sqrt(v + eps)
def _scatter_add(tgt, idx, src, axis=0):
    return tgt.clone().index_add_(axis, idx, src)
def _segment_sum(src, seg, n):
    out = torch.zeros((n,) + src.shape[1:], dtype=src.dtype)
    return out.index_add_(0, seg, src)
def _pad(x, pw):
    flat = tuple(v for pair in reversed(pw) for v in pair)
    return torch.nn.functional.pad(x, flat)

kernel_name = 'standalone__molecular_angular_gemnet__graph'

def setup_inputs():

    _w = (lambda a: (lambda t: t.to(torch.bfloat16) if t.is_floating_point() else t)(torch.as_tensor(a)))
    N, deg, De, L = 12500, 32, 4, 1
    E = N * deg
    T = E * deg
    NR = 8
    dist = torch.rand(E).to(float)
    angle = (torch.rand(T) * torch.pi).to(float)
    centers = torch.linspace(0.0, 1.0, NR).to(float)
    ang_freq = torch.arange(1, L + 1).to(float)
    return {
        "m": _w((lambda *s: torch.randn(*s, dtype=torch.bfloat16) * 0.05)(E, De)),
        "idx_in": _w((lambda lo, hi, *s: torch.randint(lo, hi, s))(0, E, T).to(torch.int64)),
        "idx_out": _w((lambda lo, hi, *s: torch.randint(lo, hi, s))(0, E, T).to(torch.int64)),
        "dist": _w(dist),
        "angle": _w(angle),
        "centers": _w(centers),
        "ang_freq": _w(ang_freq),
        "w_rbf": _w((lambda *s: torch.randn(*s, dtype=torch.bfloat16) * 0.4)(NR, De)),
        "w_sbf": _w((lambda *s: torch.randn(*s, dtype=torch.bfloat16) * 0.4)(NR * L, De)),
        "w_down": _w((lambda *s: torch.randn(*s, dtype=torch.bfloat16) * 0.4)(De, De)),
        "w_up": _w((lambda *s: torch.randn(*s, dtype=torch.bfloat16) * 0.4)(De, De)),
    }

def reference(m, idx_in, idx_out, dist, angle, centers, ang_freq, w_rbf, w_sbf, w_down, w_up):
    E, De = m.shape[0], m.shape[1]
    NR = centers.shape[0]
    L = ang_freq.shape[0]
    rbf = torch.exp(-10.0 * (dist[:, None] - centers[None, :]) ** 2)
    cbf = torch.cos(ang_freq[None, :] * angle[:, None])
    rbf_t = rbf[idx_out]
    sbf = torch.reshape(rbf_t[:, :, None] * cbf[:, None, :], (-1, NR * L))
    x = (m[idx_in] @ w_down) * (sbf @ w_sbf)
    agg = _segment_sum(x, idx_out, E)
    return m + (agg @ w_up) * (rbf @ w_rbf)
```

```asm
; @launch kernel=part_kernel grid=(256,1,1) block=(1024,1,1) lds=149992
; @launch kernel=acc_kernel grid=(256,1,1) block=(1024,1,1) lds=157408
; @launch kernel=fin_kernel grid=(1563,1,1) block=(256,1,1) lds=0
.amdgcn_target "amdgcn-amd-amdhsa--gfx950"
.text
.globl part_kernel
.p2align 8
.type part_kernel,@function
part_kernel:
    s_cmp_ge_u32 s2, 256
    s_cbranch_scc1 P_END
    s_load_dwordx4 s[4:7], s[0:1], 0
    s_load_dwordx2 s[8:9], s[0:1], 16
    s_load_dwordx2 s[10:11], s[0:1], 32
    s_load_dwordx2 s[12:13], s[0:1], 48
    s_load_dwordx2 s[14:15], s[0:1], 104
    s_setprio 3
    v_lshlrev_b32 v1, 4, v0
    v_lshlrev_b32 v2, 3, v0
    v_mov_b32 v3, 1
    v_mov_b32 v4, 0x10000
    v_mov_b32 v5, 0
    v_lshlrev_b32 v6, 2, v0
    v_lshlrev_b32 v7, 1, v0
    v_mov_b32 v12, 0
    v_mov_b32 v13, 0
    v_mov_b32 v14, 0
    v_mov_b32 v15, 0
    v_readfirstlane_b32 s50, v0
    ds_write_b128 v1, v[12:15]
    ds_write_b32 v6, v5 offset:16384
    s_movk_i32 s42, 424
    v_cmp_gt_u32 s[40:41], s42, v0
    s_waitcnt lgkmcnt(0)
    s_load_dword s36, s[12:13], 0
    s_mov_b32 s16, s6
    s_and_b32 s17, s7, 0xffff
    s_mov_b32 s18, 0x30d4000
    s_mov_b32 s19, 0x00020000
    s_mov_b32 s20, s8
    s_and_b32 s21, s9, 0xffff
    s_mov_b32 s22, 0x30d4000
    s_mov_b32 s23, 0x00020000
    s_mov_b32 s24, s10
    s_and_b32 s25, s11, 0xffff
    s_mov_b32 s26, 0x186a000
    s_mov_b32 s27, 0x00020000
    s_mov_b32 s28, s14
    s_and_b32 s29, s15, 0xffff
    s_mov_b32 s30, 0x10000000
    s_mov_b32 s31, 0x00020000
    s_mov_b32 s32, s4
    s_and_b32 s33, s5, 0xffff
    s_mov_b32 s34, 0x30d400
    s_mov_b32 s35, 0x00020000
    s_lshr_b32 s50, s50, 6
    s_mul_i32 s37, s50, 1571840
    s_mul_i32 s38, s2, 6144
    s_add_u32 s37, s37, s38
    s_lshr_b32 s38, s37, 1
    s_mul_i32 s68, s2, 1696
    s_mul_i32 s69, s2, 848
    s_add_u32 s43, s37, 0
    s_add_u32 s44, s38, 0
    buffer_load_dwordx4 v[28:31], v1, s[20:23], s43 offen nt
    buffer_load_dwordx4 v[24:27], v1, s[16:19], s43 offen nt
    buffer_load_dwordx2 v[32:33], v2, s[24:27], s44 offen nt
    s_barrier
    s_lshl_b32 s39, s2, 4
    s_add_u32 s39, s39, s50
    s_sub_u32 s42, s39, 3136
    s_cmp_ge_u32 s39, 3136
    s_cselect_b32 s39, s42, s39
    s_cselect_b32 s70, 1, 0
    s_lshl_b32 s45, s39, 10
    s_mul_hi_u32 s42, s39, 0x4924925
    s_mul_i32 s42, s42, 200
    s_sub_u32 s39, s45, s42
    s_add_u32 s45, s45, 0x4c10000
    s_mul_i32 s42, s50, 198656
    buffer_load_dwordx4 v[88:91], v1, s[32:35], s42 offen
    s_add_u32 s43, s37, 1024
    s_add_u32 s44, s38, 512
    buffer_load_dwordx4 v[38:41], v1, s[20:23], s43 offen nt
    buffer_load_dwordx4 v[34:37], v1, s[16:19], s43 offen nt
    buffer_load_dwordx2 v[42:43], v2, s[24:27], s44 offen nt
    s_add_u32 s43, s37, 2048
    s_add_u32 s44, s38, 1024
    buffer_load_dwordx4 v[48:51], v1, s[20:23], s43 offen nt
    buffer_load_dwordx4 v[44:47], v1, s[16:19], s43 offen nt
    buffer_load_dwordx2 v[52:53], v2, s[24:27], s44 offen nt
    s_add_u32 s43, s37, 3072
    s_add_u32 s44, s38, 1536
    buffer_load_dwordx4 v[58:61], v1, s[20:23], s43 offen nt
    buffer_load_dwordx4 v[54:57], v1, s[16:19], s43 offen nt
    buffer_load_dwordx2 v[62:63], v2, s[24:27], s44 offen nt
    s_add_u32 s43, s37, 4096
    s_add_u32 s44, s38, 2048
    buffer_load_dwordx4 v[68:71], v1, s[20:23], s43 offen nt
    buffer_load_dwordx4 v[64:67], v1, s[16:19], s43 offen nt
    buffer_load_dwordx2 v[72:73], v2, s[24:27], s44 offen nt
    s_add_u32 s43, s37, 5120
    s_add_u32 s44, s38, 2560
    buffer_load_dwordx4 v[78:81], v1, s[20:23], s43 offen nt
    buffer_load_dwordx4 v[74:77], v1, s[16:19], s43 offen nt
    buffer_load_dwordx2 v[82:83], v2, s[24:27], s44 offen nt
    s_add_u32 s43, s68, 50331648
    s_add_u32 s44, s69, 25165824
    s_or_b64 exec, s[40:41], 1
    buffer_load_dword v85, v6, s[20:23], s43 offen nt
    buffer_load_dword v84, v6, s[16:19], s43 offen nt
    buffer_load_ushort v86, v7, s[24:27], s44 offen nt
    s_mov_b64 exec, -1
    s_setprio 0
    s_mov_b32 s46, 0x3e22f900
    s_mov_b32 s47, 0x36036e4e
    s_mov_b32 s48, 0xfc000000
    s_mov_b32 s49, 0xffff0000
    s_mov_b32 s51, 0xffffe796
    s_mov_b32 s52, 0x00020002
    s_movk_i32 s55, 1010
    s_mov_b32 s54, 0xffffe419
    s_mov_b32 s53, 0x55555556
    s_waitcnt lgkmcnt(0)
    s_lshl_b32 s36, s36, 16
    s_waitcnt vmcnt(19)
    v_mul_hi_u32_u24 v19, 0x92cc4, v24
    v_mul_hi_u32_u24 v20, 0xa7c5b, v28
    v_mul_u32_u24 v21, 4682, v19
    v_mad_i32_i24 v24, v19, s54, v24
    v_mad_i32_i24 v28, v20, s51, v28
    v_lshrrev_b32 v21, 16, v21
    v_lshl_or_b32 v24, v28, 13, v24
    v_lshl_add_u32 v28, v20, 4, v19
    v_mad_u32_u24 v28, v21, s55, v28
    v_bfe_i32 v20, v20, 0, 1
    v_add_lshl_u32 v28, v28, 2, 2
    v_bitop3_b32 v28, v28, v20, 60 bitop3:0x78
    ds_add_u32 v28, v3 offset:0
    v_mul_hi_u32_u24 v19, 0x92cc4, v25
    v_mul_hi_u32_u24 v20, 0xa7c5b, v29
    v_mul_u32_u24 v21, 4682, v19
    v_mad_i32_i24 v25, v19, s54, v25
    v_mad_i32_i24 v29, v20, s51, v29
    v_lshrrev_b32 v21, 16, v21
    v_lshl_or_b32 v25, v29, 13, v25
    v_lshl_add_u32 v29, v20, 4, v19
    v_mad_u32_u24 v29, v21, s55, v29
    v_bfe_i32 v20, v20, 0, 1
    v_add_lshl_u32 v29, v29, 2, 2
    v_bitop3_b32 v29, v29, v20, 60 bitop3:0x78
    ds_add_u32 v29, v3 offset:0
    v_mul_hi_u32_u24 v19, 0x92cc4, v26
    v_mul_hi_u32_u24 v20, 0xa7c5b, v30
    v_mul_u32_u24 v21, 4682, v19
    v_mad_i32_i24 v26, v19, s54, v26
    v_mad_i32_i24 v30, v20, s51, v30
    v_lshrrev_b32 v21, 16, v21
    v_lshl_or_b32 v26, v30, 13, v26
    v_lshl_add_u32 v30, v20, 4, v19
    v_mad_u32_u24 v30, v21, s55, v30
    v_bfe_i32 v20, v20, 0, 1
    v_add_lshl_u32 v30, v30, 2, 2
    v_bitop3_b32 v30, v30, v20, 60 bitop3:0x78
    ds_add_u32 v30, v3 offset:0
    v_mul_hi_u32_u24 v19, 0x92cc4, v27
    v_mul_hi_u32_u24 v20, 0xa7c5b, v31
    v_mul_u32_u24 v21, 4682, v19
    v_mad_i32_i24 v27, v19, s54, v27
    v_mad_i32_i24 v31, v20, s51, v31
    v_lshrrev_b32 v21, 16, v21
    v_lshl_or_b32 v27, v31, 13, v27
    v_lshl_add_u32 v31, v20, 4, v19
    v_mad_u32_u24 v31, v21, s55, v31
    v_bfe_i32 v20, v20, 0, 1
    v_add_lshl_u32 v31, v31, 2, 2
    v_bitop3_b32 v31, v31, v20, 60 bitop3:0x78
    ds_add_u32 v31, v3 offset:0
    s_cmp_eq_u32 s36, 0x3f800000
    s_cbranch_scc1 P_NF_1
    v_lshlrev_b32 v22, 16, v32
    v_and_b32 v23, s49, v32
    v_mul_f32 v22, s36, v22
    v_mul_f32 v23, s36, v23
    v_cvt_pk_bf16_f32 v32, v22, v23
    v_lshlrev_b32 v22, 16, v33
    v_and_b32 v23, s49, v33
    v_mul_f32 v22, s36, v22
    v_mul_f32 v23, s36, v23
    v_cvt_pk_bf16_f32 v33, v22, v23
P_NF_1:
    v_lshlrev_b32 v22, 16, v32
    v_and_b32 v23, s49, v32
    v_mul_f32 v19, s46, v22
    v_mul_f32 v20, s46, v23
    v_fract_f32 v19, v19
    v_fract_f32 v20, v20
    v_fmac_f32 v19, s47, v22
    v_fmac_f32 v20, s47, v23
    v_cos_f32 v22, v19
    v_cos_f32 v23, v20
    s_nop 0
    v_cvt_pk_bf16_f32 v32, v22, v23
    v_lshlrev_b32 v22, 16, v32
    v_and_b32 v23, s49, v32
    v_cvt_pk_f16_f32 v32, v22, v23
    v_lshlrev_b32 v22, 16, v32
    v_and_or_b32 v25, v32, s48, v25
    v_and_or_b32 v24, v22, s48, v24
    v_lshrrev_b32 v32, 2, v32
    v_lshlrev_b32 v22, 16, v33
    v_and_b32 v23, s49, v33
    v_mul_f32 v19, s46, v22
    v_mul_f32 v20, s46, v23
    v_fract_f32 v19, v19
    v_fract_f32 v20, v20
    v_fmac_f32 v19, s47, v22
    v_fmac_f32 v20, s47, v23
    v_cos_f32 v22, v19
    v_cos_f32 v23, v20
    s_nop 0
    v_cvt_pk_bf16_f32 v33, v22, v23
    v_lshlrev_b32 v22, 16, v33
    v_and_b32 v23, s49, v33
    v_cvt_pk_f16_f32 v33, v22, v23
    v_lshlrev_b32 v22, 16, v33
    v_and_or_b32 v27, v33, s48, v27
    v_and_or_b32 v26, v22, s48, v26
    v_lshrrev_b32 v33, 2, v33
    s_waitcnt vmcnt(18)
    s_mov_b32 s42, 0x7fff7fff
    v_and_b32 v14, s42, v88
    v_and_b32 v15, s42, v89
    v_and_b32 v16, s42, v90
    v_and_b32 v17, s42, v91
    v_pk_max_u16 v14, v14, v16
    v_pk_max_u16 v15, v15, v17
    v_pk_max_u16 v14, v14, v15
    v_lshrrev_b32 v15, 16, v14
    v_and_b32 v14, 0xffff, v14
    v_max_u32 v14, v14, v15
    s_nop 1
    v_max_u32_dpp v14, v14, v14 row_shr:1 row_mask:0xf bank_mask:0xf bound_ctrl:0
    s_nop 1
    v_max_u32_dpp v14, v14, v14 row_shr:2 row_mask:0xf bank_mask:0xf bound_ctrl:0
    s_nop 1
    v_max_u32_dpp v14, v14, v14 row_shr:4 row_mask:0xf bank_mask:0xf bound_ctrl:0
    s_nop 1
    v_max_u32_dpp v14, v14, v14 row_shr:8 row_mask:0xf bank_mask:0xf bound_ctrl:0
    s_nop 1
    v_max_u32_dpp v14, v14, v14 row_bcast:15 row_mask:0xa bank_mask:0xf
    s_nop 1
    v_max_u32_dpp v14, v14, v14 row_bcast:31 row_mask:0xc bank_mask:0xf
    s_nop 1
    v_readlane_b32 s42, v14, 63
    s_nop 1
    v_mov_b32 v14, s42
    s_mov_b64 exec, 1
    ds_max_u32 v5, v14 offset:16516
    s_mov_b64 exec, -1
    s_waitcnt vmcnt(15)
    v_mul_hi_u32_u24 v19, 0x92cc4, v34
    v_mul_hi_u32_u24 v20, 0xa7c5b, v38
    v_mul_u32_u24 v21, 4682, v19
    v_mad_i32_i24 v34, v19, s54, v34
    v_mad_i32_i24 v38, v20, s51, v38
    v_lshrrev_b32 v21, 16, v21
    v_lshl_or_b32 v34, v38, 13, v34
    v_lshl_add_u32 v38, v20, 4, v19
    v_mad_u32_u24 v38, v21, s55, v38
    v_bfe_i32 v20, v20, 0, 1
    v_add_lshl_u32 v38, v38, 2, 2
    v_bitop3_b32 v38, v38, v20, 60 bitop3:0x78
    ds_add_u32 v38, v3 offset:0
    v_mul_hi_u32_u24 v19, 0x92cc4, v35
    v_mul_hi_u32_u24 v20, 0xa7c5b, v39
    v_mul_u32_u24 v21, 4682, v19
    v_mad_i32_i24 v35, v19, s54, v35
    v_mad_i32_i24 v39, v20, s51, v39
    v_lshrrev_b32 v21, 16, v21
    v_lshl_or_b32 v35, v39, 13, v35
    v_lshl_add_u32 v39, v20, 4, v19
    v_mad_u32_u24 v39, v21, s55, v39
    v_bfe_i32 v20, v20, 0, 1
    v_add_lshl_u32 v39, v39, 2, 2
    v_bitop3_b32 v39, v39, v20, 60 bitop3:0x78
    ds_add_u32 v39, v3 offset:0
    v_mul_hi_u32_u24 v19, 0x92cc4, v36
    v_mul_hi_u32_u24 v20, 0xa7c5b, v40
    v_mul_u32_u24 v21, 4682, v19
    v_mad_i32_i24 v36, v19, s54, v36
    v_mad_i32_i24 v40, v20, s51, v40
    v_lshrrev_b32 v21, 16, v21
    v_lshl_or_b32 v36, v40, 13, v36
    v_lshl_add_u32 v40, v20, 4, v19
    v_mad_u32_u24 v40, v21, s55, v40
    v_bfe_i32 v20, v20, 0, 1
    v_add_lshl_u32 v40, v40, 2, 2
    v_bitop3_b32 v40, v40, v20, 60 bitop3:0x78
    ds_add_u32 v40, v3 offset:0
    v_mul_hi_u32_u24 v19, 0x92cc4, v37
    v_mul_hi_u32_u24 v20, 0xa7c5b, v41
    v_mul_u32_u24 v21, 4682, v19
    v_mad_i32_i24 v37, v19, s54, v37
    v_mad_i32_i24 v41, v20, s51, v41
    v_lshrrev_b32 v21, 16, v21
    v_lshl_or_b32 v37, v41, 13, v37
    v_lshl_add_u32 v41, v20, 4, v19
    v_mad_u32_u24 v41, v21, s55, v41
    v_bfe_i32 v20, v20, 0, 1
    v_add_lshl_u32 v41, v41, 2, 2
    v_bitop3_b32 v41, v41, v20, 60 bitop3:0x78
    ds_add_u32 v41, v3 offset:0
    s_cmp_eq_u32 s36, 0x3f800000
    s_cbranch_scc1 P_NF_2
    v_lshlrev_b32 v22, 16, v42
    v_and_b32 v23, s49, v42
    v_mul_f32 v22, s36, v22
    v_mul_f32 v23, s36, v23
    v_cvt_pk_bf16_f32 v42, v22, v23
    v_lshlrev_b32 v22, 16, v43
    v_and_b32 v23, s49, v43
    v_mul_f32 v22, s36, v22
    v_mul_f32 v23, s36, v23
    v_cvt_pk_bf16_f32 v43, v22, v23
P_NF_2:
    v_lshlrev_b32 v22, 16, v42
    v_and_b32 v23, s49, v42
    v_mul_f32 v19, s46, v22
    v_mul_f32 v20, s46, v23
    v_fract_f32 v19, v19
    v_fract_f32 v20, v20
    v_fmac_f32 v19, s47, v22
    v_fmac_f32 v20, s47, v23
    v_cos_f32 v22, v19
    v_cos_f32 v23, v20
    s_nop 0
    v_cvt_pk_bf16_f32 v42, v22, v23
    v_lshlrev_b32 v22, 16, v42
    v_and_b32 v23, s49, v42
    v_cvt_pk_f16_f32 v42, v22, v23
    v_lshlrev_b32 v22, 16, v42
    v_and_or_b32 v35, v42, s48, v35
    v_and_or_b32 v34, v22, s48, v34
    v_lshrrev_b32 v42, 2, v42
    v_lshlrev_b32 v22, 16, v43
    v_and_b32 v23, s49, v43
    v_mul_f32 v19, s46, v22
    v_mul_f32 v20, s46, v23
    v_fract_f32 v19, v19
    v_fract_f32 v20, v20
    v_fmac_f32 v19, s47, v22
    v_fmac_f32 v20, s47, v23
    v_cos_f32 v22, v19
    v_cos_f32 v23, v20
    s_nop 0
    v_cvt_pk_bf16_f32 v43, v22, v23
    v_lshlrev_b32 v22, 16, v43
    v_and_b32 v23, s49, v43
    v_cvt_pk_f16_f32 v43, v22, v23
    v_lshlrev_b32 v22, 16, v43
    v_and_or_b32 v37, v43, s48, v37
    v_and_or_b32 v36, v22, s48, v36
    v_lshrrev_b32 v43, 2, v43
    s_waitcnt vmcnt(12)
    v_mul_hi_u32_u24 v19, 0x92cc4, v44
    v_mul_hi_u32_u24 v20, 0xa7c5b, v48
    v_mul_u32_u24 v21, 4682, v19
    v_mad_i32_i24 v44, v19, s54, v44
    v_mad_i32_i24 v48, v20, s51, v48
    v_lshrrev_b32 v21, 16, v21
    v_lshl_or_b32 v44, v48, 13, v44
    v_lshl_add_u32 v48, v20, 4, v19
    v_mad_u32_u24 v48, v21, s55, v48
    v_bfe_i32 v20, v20, 0, 1
    v_add_lshl_u32 v48, v48, 2, 2
    v_bitop3_b32 v48, v48, v20, 60 bitop3:0x78
    ds_add_u32 v48, v3 offset:0
    v_mul_hi_u32_u24 v19, 0x92cc4, v45
    v_mul_hi_u32_u24 v20, 0xa7c5b, v49
    v_mul_u32_u24 v21, 4682, v19
    v_mad_i32_i24 v45, v19, s54, v45
    v_mad_i32_i24 v49, v20, s51, v49
    v_lshrrev_b32 v21, 16, v21
    v_lshl_or_b32 v45, v49, 13, v45
    v_lshl_add_u32 v49, v20, 4, v19
    v_mad_u32_u24 v49, v21, s55, v49
    v_bfe_i32 v20, v20, 0, 1
    v_add_lshl_u32 v49, v49, 2, 2
    v_bitop3_b32 v49, v49, v20, 60 bitop3:0x78
    ds_add_u32 v49, v3 offset:0
    v_mul_hi_u32_u24 v19, 0x92cc4, v46
    v_mul_hi_u32_u24 v20, 0xa7c5b, v50
    v_mul_u32_u24 v21, 4682, v19
    v_mad_i32_i24 v46, v19, s54, v46
    v_mad_i32_i24 v50, v20, s51, v50
    v_lshrrev_b32 v21, 16, v21
    v_lshl_or_b32 v46, v50, 13, v46
    v_lshl_add_u32 v50, v20, 4, v19
    v_mad_u32_u24 v50, v21, s55, v50
    v_bfe_i32 v20, v20, 0, 1
    v_add_lshl_u32 v50, v50, 2, 2
    v_bitop3_b32 v50, v50, v20, 60 bitop3:0x78
    ds_add_u32 v50, v3 offset:0
    v_mul_hi_u32_u24 v19, 0x92cc4, v47
    v_mul_hi_u32_u24 v20, 0xa7c5b, v51
    v_mul_u32_u24 v21, 4682, v19
    v_mad_i32_i24 v47, v19, s54, v47
    v_mad_i32_i24 v51, v20, s51, v51
    v_lshrrev_b32 v21, 16, v21
    v_lshl_or_b32 v47, v51, 13, v47
    v_lshl_add_u32 v51, v20, 4, v19
    v_mad_u32_u24 v51, v21, s55, v51
    v_bfe_i32 v20, v20, 0, 1
    v_add_lshl_u32 v51, v51, 2, 2
    v_bitop3_b32 v51, v51, v20, 60 bitop3:0x78
    ds_add_u32 v51, v3 offset:0
    s_cmp_eq_u32 s36, 0x3f800000
    s_cbranch_scc1 P_NF_3
    v_lshlrev_b32 v22, 16, v52
    v_and_b32 v23, s49, v52
    v_mul_f32 v22, s36, v22
    v_mul_f32 v23, s36, v23
    v_cvt_pk_bf16_f32 v52, v22, v23
    v_lshlrev_b32 v22, 16, v53
    v_and_b32 v23, s49, v53
    v_mul_f32 v22, s36, v22
    v_mul_f32 v23, s36, v23
    v_cvt_pk_bf16_f32 v53, v22, v23
P_NF_3:
    v_lshlrev_b32 v22, 16, v52
    v_and_b32 v23, s49, v52
    v_mul_f32 v19, s46, v22
    v_mul_f32 v20, s46, v23
    v_fract_f32 v19, v19
    v_fract_f32 v20, v20
    v_fmac_f32 v19, s47, v22
    v_fmac_f32 v20, s47, v23
    v_cos_f32 v22, v19
    v_cos_f32 v23, v20
    s_nop 0
    v_cvt_pk_bf16_f32 v52, v22, v23
    v_lshlrev_b32 v22, 16, v52
    v_and_b32 v23, s49, v52
    v_cvt_pk_f16_f32 v52, v22, v23
    v_lshlrev_b32 v22, 16, v52
    v_and_or_b32 v45, v52, s48, v45
    v_and_or_b32 v44, v22, s48, v44
    v_lshrrev_b32 v52, 2, v52
    v_lshlrev_b32 v22, 16, v53
    v_and_b32 v23, s49, v53
    v_mul_f32 v19, s46, v22
    v_mul_f32 v20, s46, v23
    v_fract_f32 v19, v19
    v_fract_f32 v20, v20
    v_fmac_f32 v19, s47, v22
    v_fmac_f32 v20, s47, v23
    v_cos_f32 v22, v19
    v_cos_f32 v23, v20
    s_nop 0
    v_cvt_pk_bf16_f32 v53, v22, v23
    v_lshlrev_b32 v22, 16, v53
    v_and_b32 v23, s49, v53
    v_cvt_pk_f16_f32 v53, v22, v23
    v_lshlrev_b32 v22, 16, v53
    v_and_or_b32 v47, v53, s48, v47
    v_and_or_b32 v46, v22, s48, v46
    v_lshrrev_b32 v53, 2, v53
    s_waitcnt vmcnt(9)
    v_mul_hi_u32_u24 v19, 0x92cc4, v54
    v_mul_hi_u32_u24 v20, 0xa7c5b, v58
    v_mul_u32_u24 v21, 4682, v19
    v_mad_i32_i24 v54, v19, s54, v54
    v_mad_i32_i24 v58, v20, s51, v58
    v_lshrrev_b32 v21, 16, v21
    v_lshl_or_b32 v54, v58, 13, v54
    v_lshl_add_u32 v58, v20, 4, v19
    v_mad_u32_u24 v58, v21, s55, v58
    v_bfe_i32 v20, v20, 0, 1
    v_add_lshl_u32 v58, v58, 2, 2
    v_bitop3_b32 v58, v58, v20, 60 bitop3:0x78
    ds_add_u32 v58, v3 offset:0
    v_mul_hi_u32_u24 v19, 0x92cc4, v55
    v_mul_hi_u32_u24 v20, 0xa7c5b, v59
    v_mul_u32_u24 v21, 4682, v19
    v_mad_i32_i24 v55, v19, s54, v55
    v_mad_i32_i24 v59, v20, s51, v59
    v_lshrrev_b32 v21, 16, v21
    v_lshl_or_b32 v55, v59, 13, v55
    v_lshl_add_u32 v59, v20, 4, v19
    v_mad_u32_u24 v59, v21, s55, v59
    v_bfe_i32 v20, v20, 0, 1
    v_add_lshl_u32 v59, v59, 2, 2
    v_bitop3_b32 v59, v59, v20, 60 bitop3:0x78
    ds_add_u32 v59, v3 offset:0
    v_mul_hi_u32_u24 v19, 0x92cc4, v56
    v_mul_hi_u32_u24 v20, 0xa7c5b, v60
    v_mul_u32_u24 v21, 4682, v19
    v_mad_i32_i24 v56, v19, s54, v56
    v_mad_i32_i24 v60, v20, s51, v60
    v_lshrrev_b32 v21, 16, v21
    v_lshl_or_b32 v56, v60, 13, v56
    v_lshl_add_u32 v60, v20, 4, v19
    v_mad_u32_u24 v60, v21, s55, v60
    v_bfe_i32 v20, v20, 0, 1
    v_add_lshl_u32 v60, v60, 2, 2
    v_bitop3_b32 v60, v60, v20, 60 bitop3:0x78
    ds_add_u32 v60, v3 offset:0
    v_mul_hi_u32_u24 v19, 0x92cc4, v57
    v_mul_hi_u32_u24 v20, 0xa7c5b, v61
    v_mul_u32_u24 v21, 4682, v19
    v_mad_i32_i24 v57, v19, s54, v57
    v_mad_i32_i24 v61, v20, s51, v61
    v_lshrrev_b32 v21, 16, v21
    v_lshl_or_b32 v57, v61, 13, v57
    v_lshl_add_u32 v61, v20, 4, v19
    v_mad_u32_u24 v61, v21, s55, v61
    v_bfe_i32 v20, v20, 0, 1
    v_add_lshl_u32 v61, v61, 2, 2
    v_bitop3_b32 v61, v61, v20, 60 bitop3:0x78
    ds_add_u32 v61, v3 offset:0
    s_cmp_eq_u32 s36, 0x3f800000
    s_cbranch_scc1 P_NF_4
    v_lshlrev_b32 v22, 16, v62
    v_and_b32 v23, s49, v62
    v_mul_f32 v22, s36, v22
    v_mul_f32 v23, s36, v23
    v_cvt_pk_bf16_f32 v62, v22, v23
    v_lshlrev_b32 v22, 16, v63
    v_and_b32 v23, s49, v63
    v_mul_f32 v22, s36, v22
    v_mul_f32 v23, s36, v23
    v_cvt_pk_bf16_f32 v63, v22, v23
P_NF_4:
    v_lshlrev_b32 v22, 16, v62
    v_and_b32 v23, s49, v62
    v_mul_f32 v19, s46, v22
    v_mul_f32 v20, s46, v23
    v_fract_f32 v19, v19
    v_fract_f32 v20, v20
    v_fmac_f32 v19, s47, v22
    v_fmac_f32 v20, s47, v23
    v_cos_f32 v22, v19
    v_cos_f32 v23, v20
    s_nop 0
    v_cvt_pk_bf16_f32 v62, v22, v23
    v_lshlrev_b32 v22, 16, v62
    v_and_b32 v23, s49, v62
    v_cvt_pk_f16_f32 v62, v22, v23
    v_lshlrev_b32 v22, 16, v62
    v_and_or_b32 v55, v62, s48, v55
    v_and_or_b32 v54, v22, s48, v54
    v_lshrrev_b32 v62, 2, v62
    v_lshlrev_b32 v22, 16, v63
    v_and_b32 v23, s49, v63
    v_mul_f32 v19, s46, v22
    v_mul_f32 v20, s46, v23
    v_fract_f32 v19, v19
    v_fract_f32 v20, v20
    v_fmac_f32 v19, s47, v22
    v_fmac_f32 v20, s47, v23
    v_cos_f32 v22, v19
    v_cos_f32 v23, v20
    s_nop 0
    v_cvt_pk_bf16_f32 v63, v22, v23
    v_lshlrev_b32 v22, 16, v63
    v_and_b32 v23, s49, v63
    v_cvt_pk_f16_f32 v63, v22, v23
    v_lshlrev_b32 v22, 16, v63
    v_and_or_b32 v57, v63, s48, v57
    v_and_or_b32 v56, v22, s48, v56
    v_lshrrev_b32 v63, 2, v63
    s_waitcnt vmcnt(6)
    v_mul_hi_u32_u24 v19, 0x92cc4, v64
    v_mul_hi_u32_u24 v20, 0xa7c5b, v68
    v_mul_u32_u24 v21, 4682, v19
    v_mad_i32_i24 v64, v19, s54, v64
    v_mad_i32_i24 v68, v20, s51, v68
    v_lshrrev_b32 v21, 16, v21
    v_lshl_or_b32 v64, v68, 13, v64
    v_lshl_add_u32 v68, v20, 4, v19
    v_mad_u32_u24 v68, v21, s55, v68
    v_bfe_i32 v20, v20, 0, 1
    v_add_lshl_u32 v68, v68, 2, 2
    v_bitop3_b32 v68, v68, v20, 60 bitop3:0x78
    ds_add_u32 v68, v3 offset:0
    v_mul_hi_u32_u24 v19, 0x92cc4, v65
    v_mul_hi_u32_u24 v20, 0xa7c5b, v69
    v_mul_u32_u24 v21, 4682, v19
    v_mad_i32_i24 v65, v19, s54, v65
    v_mad_i32_i24 v69, v20, s51, v69
    v_lshrrev_b32 v21, 16, v21
    v_lshl_or_b32 v65, v69, 13, v65
    v_lshl_add_u32 v69, v20, 4, v19
    v_mad_u32_u24 v69, v21, s55, v69
    v_bfe_i32 v20, v20, 0, 1
    v_add_lshl_u32 v69, v69, 2, 2
    v_bitop3_b32 v69, v69, v20, 60 bitop3:0x78
    ds_add_u32 v69, v3 offset:0
    v_mul_hi_u32_u24 v19, 0x92cc4, v66
    v_mul_hi_u32_u24 v20, 0xa7c5b, v70
    v_mul_u32_u24 v21, 4682, v19
    v_mad_i32_i24 v66, v19, s54, v66
    v_mad_i32_i24 v70, v20, s51, v70
    v_lshrrev_b32 v21, 16, v21
    v_lshl_or_b32 v66, v70, 13, v66
    v_lshl_add_u32 v70, v20, 4, v19
    v_mad_u32_u24 v70, v21, s55, v70
    v_bfe_i32 v20, v20, 0, 1
    v_add_lshl_u32 v70, v70, 2, 2
    v_bitop3_b32 v70, v70, v20, 60 bitop3:0x78
    ds_add_u32 v70, v3 offset:0
    v_mul_hi_u32_u24 v19, 0x92cc4, v67
    v_mul_hi_u32_u24 v20, 0xa7c5b, v71
    v_mul_u32_u24 v21, 4682, v19
    v_mad_i32_i24 v67, v19, s54, v67
    v_mad_i32_i24 v71, v20, s51, v71
    v_lshrrev_b32 v21, 16, v21
    v_lshl_or_b32 v67, v71, 13, v67
    v_lshl_add_u32 v71, v20, 4, v19
    v_mad_u32_u24 v71, v21, s55, v71
    v_bfe_i32 v20, v20, 0, 1
    v_add_lshl_u32 v71, v71, 2, 2
    v_bitop3_b32 v71, v71, v20, 60 bitop3:0x78
    ds_add_u32 v71, v3 offset:0
    s_cmp_eq_u32 s36, 0x3f800000
    s_cbranch_scc1 P_NF_5
    v_lshlrev_b32 v22, 16, v72
    v_and_b32 v23, s49, v72
    v_mul_f32 v22, s36, v22
    v_mul_f32 v23, s36, v23
    v_cvt_pk_bf16_f32 v72, v22, v23
    v_lshlrev_b32 v22, 16, v73
    v_and_b32 v23, s49, v73
    v_mul_f32 v22, s36, v22
    v_mul_f32 v23, s36, v23
    v_cvt_pk_bf16_f32 v73, v22, v23
P_NF_5:
    v_lshlrev_b32 v22, 16, v72
    v_and_b32 v23, s49, v72
    v_mul_f32 v19, s46, v22
    v_mul_f32 v20, s46, v23
    v_fract_f32 v19, v19
    v_fract_f32 v20, v20
    v_fmac_f32 v19, s47, v22
    v_fmac_f32 v20, s47, v23
    v_cos_f32 v22, v19
    v_cos_f32 v23, v20
    s_nop 0
    v_cvt_pk_bf16_f32 v72, v22, v23
    v_lshlrev_b32 v22, 16, v72
    v_and_b32 v23, s49, v72
    v_cvt_pk_f16_f32 v72, v22, v23
    v_lshlrev_b32 v22, 16, v72
    v_and_or_b32 v65, v72, s48, v65
    v_and_or_b32 v64, v22, s48, v64
    v_lshrrev_b32 v72, 2, v72
    v_lshlrev_b32 v22, 16, v73
    v_and_b32 v23, s49, v73
    v_mul_f32 v19, s46, v22
    v_mul_f32 v20, s46, v23
    v_fract_f32 v19, v19
    v_fract_f32 v20, v20
    v_fmac_f32 v19, s47, v22
    v_fmac_f32 v20, s47, v23
    v_cos_f32 v22, v19
    v_cos_f32 v23, v20
    s_nop 0
    v_cvt_pk_bf16_f32 v73, v22, v23
    v_lshlrev_b32 v22, 16, v73
    v_and_b32 v23, s49, v73
    v_cvt_pk_f16_f32 v73, v22, v23
    v_lshlrev_b32 v22, 16, v73
    v_and_or_b32 v67, v73, s48, v67
    v_and_or_b32 v66, v22, s48, v66
    v_lshrrev_b32 v73, 2, v73
    s_waitcnt vmcnt(3)
    v_mul_hi_u32_u24 v19, 0x92cc4, v74
    v_mul_hi_u32_u24 v20, 0xa7c5b, v78
    v_mul_u32_u24 v21, 4682, v19
    v_mad_i32_i24 v74, v19, s54, v74
    v_mad_i32_i24 v78, v20, s51, v78
    v_lshrrev_b32 v21, 16, v21
    v_lshl_or_b32 v74, v78, 13, v74
    v_lshl_add_u32 v78, v20, 4, v19
    v_mad_u32_u24 v78, v21, s55, v78
    v_bfe_i32 v20, v20, 0, 1
    v_add_lshl_u32 v78, v78, 2, 2
    v_bitop3_b32 v78, v78, v20, 60 bitop3:0x78
    ds_add_u32 v78, v3 offset:0
    v_mul_hi_u32_u24 v19, 0x92cc4, v75
    v_mul_hi_u32_u24 v20, 0xa7c5b, v79
    v_mul_u32_u24 v21, 4682, v19
    v_mad_i32_i24 v75, v19, s54, v75
    v_mad_i32_i24 v79, v20, s51, v79
    v_lshrrev_b32 v21, 16, v21
    v_lshl_or_b32 v75, v79, 13, v75
    v_lshl_add_u32 v79, v20, 4, v19
    v_mad_u32_u24 v79, v21, s55, v79
    v_bfe_i32 v20, v20, 0, 1
    v_add_lshl_u32 v79, v79, 2, 2
    v_bitop3_b32 v79, v79, v20, 60 bitop3:0x78
    ds_add_u32 v79, v3 offset:0
    v_mul_hi_u32_u24 v19, 0x92cc4, v76
    v_mul_hi_u32_u24 v20, 0xa7c5b, v80
    v_mul_u32_u24 v21, 4682, v19
    v_mad_i32_i24 v76, v19, s54, v76
    v_mad_i32_i24 v80, v20, s51, v80
    v_lshrrev_b32 v21, 16, v21
    v_lshl_or_b32 v76, v80, 13, v76
    v_lshl_add_u32 v80, v20, 4, v19
    v_mad_u32_u24 v80, v21, s55, v80
    v_bfe_i32 v20, v20, 0, 1
    v_add_lshl_u32 v80, v80, 2, 2
    v_bitop3_b32 v80, v80, v20, 60 bitop3:0x78
    ds_add_u32 v80, v3 offset:0
    v_mul_hi_u32_u24 v19, 0x92cc4, v77
    v_mul_hi_u32_u24 v20, 0xa7c5b, v81
    v_mul_u32_u24 v21, 4682, v19
    v_mad_i32_i24 v77, v19, s54, v77
    v_mad_i32_i24 v81, v20, s51, v81
    v_lshrrev_b32 v21, 16, v21
    v_lshl_or_b32 v77, v81, 13, v77
    v_lshl_add_u32 v81, v20, 4, v19
    v_mad_u32_u24 v81, v21, s55, v81
    v_bfe_i32 v20, v20, 0, 1
    v_add_lshl_u32 v81, v81, 2, 2
    v_bitop3_b32 v81, v81, v20, 60 bitop3:0x78
    ds_add_u32 v81, v3 offset:0
    s_cmp_eq_u32 s36, 0x3f800000
    s_cbranch_scc1 P_NF_6
    v_lshlrev_b32 v22, 16, v82
    v_and_b32 v23, s49, v82
    v_mul_f32 v22, s36, v22
    v_mul_f32 v23, s36, v23
    v_cvt_pk_bf16_f32 v82, v22, v23
    v_lshlrev_b32 v22, 16, v83
    v_and_b32 v23, s49, v83
    v_mul_f32 v22, s36, v22
    v_mul_f32 v23, s36, v23
    v_cvt_pk_bf16_f32 v83, v22, v23
P_NF_6:
    v_lshlrev_b32 v22, 16, v82
    v_and_b32 v23, s49, v82
    v_mul_f32 v19, s46, v22
    v_mul_f32 v20, s46, v23
    v_fract_f32 v19, v19
    v_fract_f32 v20, v20
    v_fmac_f32 v19, s47, v22
    v_fmac_f32 v20, s47, v23
    v_cos_f32 v22, v19
    v_cos_f32 v23, v20
    s_nop 0
    v_cvt_pk_bf16_f32 v82, v22, v23
    v_lshlrev_b32 v22, 16, v82
    v_and_b32 v23, s49, v82
    v_cvt_pk_f16_f32 v82, v22, v23
    v_lshlrev_b32 v22, 16, v82
    v_and_or_b32 v75, v82, s48, v75
    v_and_or_b32 v74, v22, s48, v74
    v_lshrrev_b32 v82, 2, v82
    v_lshlrev_b32 v22, 16, v83
    v_and_b32 v23, s49, v83
    v_mul_f32 v19, s46, v22
    v_mul_f32 v20, s46, v23
    v_fract_f32 v19, v19
    v_fract_f32 v20, v20
    v_fmac_f32 v19, s47, v22
    v_fmac_f32 v20, s47, v23
    v_cos_f32 v22, v19
    v_cos_f32 v23, v20
    s_nop 0
    v_cvt_pk_bf16_f32 v83, v22, v23
    v_lshlrev_b32 v22, 16, v83
    v_and_b32 v23, s49, v83
    v_cvt_pk_f16_f32 v83, v22, v23
    v_lshlrev_b32 v22, 16, v83
    v_and_or_b32 v77, v83, s48, v77
    v_and_or_b32 v76, v22, s48, v76
    v_lshrrev_b32 v83, 2, v83
    s_waitcnt vmcnt(0)
    s_mov_b64 exec, s[40:41]
    s_cbranch_execz P_MS_7
    v_mul_hi_u32_u24 v19, 0x92cc4, v84
    v_mul_hi_u32_u24 v20, 0xa7c5b, v85
    v_mul_u32_u24 v21, 4682, v19
    v_mad_i32_i24 v84, v19, s54, v84
    v_mad_i32_i24 v85, v20, s51, v85
    v_lshrrev_b32 v21, 16, v21
    v_lshl_or_b32 v84, v85, 13, v84
    v_lshl_add_u32 v85, v20, 4, v19
    v_mad_u32_u24 v85, v21, s55, v85
    v_bfe_i32 v20, v20, 0, 1
    v_add_lshl_u32 v85, v85, 2, 2
    v_bitop3_b32 v85, v85, v20, 60 bitop3:0x78
    ds_add_u32 v85, v3 offset:0
    s_cmp_eq_u32 s36, 0x3f800000
    s_cbranch_scc1 P_NF_8
    v_lshlrev_b32 v22, 16, v86
    v_and_b32 v23, s49, v86
    v_mul_f32 v22, s36, v22
    v_mul_f32 v23, s36, v23
    v_cvt_pk_bf16_f32 v86, v22, v23
P_NF_8:
    v_lshlrev_b32 v22, 16, v86
    v_and_b32 v23, s49, v86
    v_mul_f32 v19, s46, v22
    v_mul_f32 v20, s46, v23
    v_fract_f32 v19, v19
    v_fract_f32 v20, v20
    v_fmac_f32 v19, s47, v22
    v_fmac_f32 v20, s47, v23
    v_cos_f32 v22, v19
    v_cos_f32 v23, v20
    s_nop 0
    v_cvt_pk_bf16_f32 v86, v22, v23
    v_lshlrev_b32 v22, 16, v86
    v_and_b32 v23, s49, v86
    v_cvt_pk_f16_f32 v86, v22, v23
    v_lshlrev_b32 v22, 16, v86
    v_and_or_b32 v84, v22, s48, v84
    v_lshrrev_b32 v86, 2, v86
P_MS_7:
    s_mov_b64 exec, -1
    s_add_u32 s43, s37, 25165824
    s_add_u32 s44, s38, 12582912
    buffer_load_dwordx4 v[92:95], v1, s[20:23], s43 offen nt
    buffer_load_dwordx4 v[88:91], v1, s[16:19], s43 offen nt
    buffer_load_dwordx2 v[96:97], v2, s[24:27], s44 offen nt
    s_waitcnt lgkmcnt(0)
    s_barrier
    ds_read_b128 v[8:11], v1 offset:0
    v_and_b32 v13, 63, v0
    v_cmp_lt_u32 vcc, s50, v13
    v_lshlrev_b32 v13, 2, v13
    s_and_b64 s[56:57], vcc, 0xffff
    s_waitcnt lgkmcnt(0)
    v_add_u32 v9, v8, v9
    v_add_u32 v10, v9, v10
    v_add_u32 v11, v10, v11
    v_mov_b32 v12, v11
    s_nop 1
    v_add_u32_dpp v12, v12, v12 row_shr:1 row_mask:0xf bank_mask:0xf bound_ctrl:0
    s_nop 1
    v_add_u32_dpp v12, v12, v12 row_shr:2 row_mask:0xf bank_mask:0xf bound_ctrl:0
    s_nop 1
    v_add_u32_dpp v12, v12, v12 row_shr:4 row_mask:0xf bank_mask:0xf bound_ctrl:0
    s_nop 1
    v_add_u32_dpp v12, v12, v12 row_shr:8 row_mask:0xf bank_mask:0xf bound_ctrl:0
    s_nop 1
    v_add_u32_dpp v12, v12, v12 row_bcast:15 row_mask:0xa bank_mask:0xf
    s_nop 1
    v_add_u32_dpp v12, v12, v12 row_bcast:31 row_mask:0xc bank_mask:0xf
    s_nop 1
    v_readlane_b32 s42, v12, 63
    s_nop 1
    v_mov_b32 v14, s42
    s_mov_b64 exec, s[56:57]
    ds_add_u32 v13, v14 offset:16384
    s_mov_b64 exec, -1
    s_lshl_b32 s42, s50, 2
    v_mov_b32 v13, s42
    v_sub_u32 v12, v12, v11
    s_waitcnt lgkmcnt(0)
    s_barrier
    ds_read_b32 v13, v13 offset:16384
    s_waitcnt lgkmcnt(0)
    v_add_u32 v12, v12, v13
    v_add_u32 v11, v12, v10
    v_add_u32 v10, v12, v9
    v_add_u32 v9, v12, v8
    v_mov_b32 v8, v12
    ds_write_b128 v1, v[8:11] offset:0
    s_waitcnt lgkmcnt(0)
    s_barrier
    ds_add_rtn_u32 v8, v28, v3 offset:0
    ds_add_rtn_u32 v9, v29, v3 offset:0
    ds_add_rtn_u32 v10, v30, v3 offset:0
    ds_add_rtn_u32 v11, v31, v3 offset:0
    ds_add_rtn_u32 v12, v38, v3 offset:0
    ds_add_rtn_u32 v13, v39, v3 offset:0
    ds_add_rtn_u32 v14, v40, v3 offset:0
    ds_add_rtn_u32 v15, v41, v3 offset:0
    s_waitcnt lgkmcnt(4)
    s_add_u32 s43, s37, 25166848
    s_add_u32 s44, s38, 12583424
    buffer_load_dwordx4 v[102:105], v1, s[20:23], s43 offen nt
    buffer_load_dwordx4 v[98:101], v1, s[16:19], s43 offen nt
    buffer_load_dwordx2 v[106:107], v2, s[24:27], s44 offen nt
    v_and_b32 v8, 0xffff, v8
    v_mul_hi_u32 v16, v8, s53
    v_lshlrev_b32 v17, 2, v8
    v_add_u32 v8, v16, v8
    ds_write_b32 v17, v24 offset:49984
    ds_write_b8 v8, v32 offset:16640
    v_and_b32 v9, 0xffff, v9
    v_mul_hi_u32 v16, v9, s53
    v_lshlrev_b32 v18, 2, v9
    v_add_u32 v9, v16, v9
    ds_write_b32 v18, v25 offset:49984
    ds_write_b8_d16_hi v9, v32 offset:16640
    v_and_b32 v10, 0xffff, v10
    v_mul_hi_u32 v16, v10, s53
    v_lshlrev_b32 v17, 2, v10
    v_add_u32 v10, v16, v10
    ds_write_b32 v17, v26 offset:49984
    ds_write_b8 v10, v33 offset:16640
    v_and_b32 v11, 0xffff, v11
    v_mul_hi_u32 v16, v11, s53
    v_lshlrev_b32 v18, 2, v11
    v_add_u32 v11, v16, v11
    ds_write_b32 v18, v27 offset:49984
    ds_write_b8_d16_hi v11, v33 offset:16640
    ds_add_rtn_u32 v8, v48, v3 offset:0
    ds_add_rtn_u32 v9, v49, v3 offset:0
    ds_add_rtn_u32 v10, v50, v3 offset:0
    ds_add_rtn_u32 v11, v51, v3 offset:0
    s_waitcnt lgkmcnt(4)
    s_add_u32 s43, s37, 25167872
    s_add_u32 s44, s38, 12583936
    buffer_load_dwordx4 v[112:115], v1, s[20:23], s43 offen nt
    buffer_load_dwordx4 v[108:111], v1, s[16:19], s43 offen nt
    buffer_load_dwordx2 v[116:117], v2, s[24:27], s44 offen nt
    v_and_b32 v12, 0xffff, v12
    v_mul_hi_u32 v16, v12, s53
    v_lshlrev_b32 v17, 2, v12
    v_add_u32 v12, v16, v12
    ds_write_b32 v17, v34 offset:49984
    ds_write_b8 v12, v42 offset:16640
    v_and_b32 v13, 0xffff, v13
    v_mul_hi_u32 v16, v13, s53
    v_lshlrev_b32 v18, 2, v13
    v_add_u32 v13, v16, v13
    ds_write_b32 v18, v35 offset:49984
    ds_write_b8_d16_hi v13, v42 offset:16640
    v_and_b32 v14, 0xffff, v14
    v_mul_hi_u32 v16, v14, s53
    v_lshlrev_b32 v17, 2, v14
    v_add_u32 v14, v16, v14
    ds_write_b32 v17, v36 offset:49984
    ds_write_b8 v14, v43 offset:16640
    v_and_b32 v15, 0xffff, v15
    v_mul_hi_u32 v16, v15, s53
    v_lshlrev_b32 v18, 2, v15
    v_add_u32 v15, v16, v15
    ds_write_b32 v18, v37 offset:49984
    ds_write_b8_d16_hi v15, v43 offset:16640
    ds_add_rtn_u32 v12, v58, v3 offset:0
    ds_add_rtn_u32 v13, v59, v3 offset:0
    ds_add_rtn_u32 v14, v60, v3 offset:0
    ds_add_rtn_u32 v15, v61, v3 offset:0
    s_waitcnt lgkmcnt(4)
    s_add_u32 s43, s37, 25168896
    s_add_u32 s44, s38, 12584448
    buffer_load_dwordx4 v[122:125], v1, s[20:23], s43 offen nt
    buffer_load_dwordx4 v[118:121], v1, s[16:19], s43 offen nt
    buffer_load_dwordx2 v[126:127], v2, s[24:27], s44 offen nt
    v_and_b32 v8, 0xffff, v8
    v_mul_hi_u32 v16, v8, s53
    v_lshlrev_b32 v17, 2, v8
    v_add_u32 v8, v16, v8
    ds_write_b32 v17, v44 offset:49984
    ds_write_b8 v8, v52 offset:16640
    v_and_b32 v9, 0xffff, v9
    v_mul_hi_u32 v16, v9, s53
    v_lshlrev_b32 v18, 2, v9
    v_add_u32 v9, v16, v9
    ds_write_b32 v18, v45 offset:49984
    ds_write_b8_d16_hi v9, v52 offset:16640
    v_and_b32 v10, 0xffff, v10
    v_mul_hi_u32 v16, v10, s53
    v_lshlrev_b32 v17, 2, v10
    v_add_u32 v10, v16, v10
    ds_write_b32 v17, v46 offset:49984
    ds_write_b8 v10, v53 offset:16640
    v_and_b32 v11, 0xffff, v11
    v_mul_hi_u32 v16, v11, s53
    v_lshlrev_b32 v18, 2, v11
    v_add_u32 v11, v16, v11
    ds_write_b32 v18, v47 offset:49984
    ds_write_b8_d16_hi v11, v53 offset:16640
    s_waitcnt vmcnt(9)
    v_mul_hi_u32_u24 v19, 0x92cc4, v88
    v_mul_hi_u32_u24 v20, 0xa7c5b, v92
    v_mul_u32_u24 v21, 4682, v19
    v_mad_i32_i24 v88, v19, s54, v88
    v_mad_i32_i24 v92, v20, s51, v92
    v_lshrrev_b32 v21, 16, v21
    v_lshl_or_b32 v88, v92, 13, v88
    v_lshl_add_u32 v92, v20, 4, v19
    v_mad_u32_u24 v92, v21, s55, v92
    v_bfe_i32 v20, v20, 0, 1
    v_add_lshl_u32 v92, v92, 2, 2
    v_bitop3_b32 v92, v92, v20, 60 bitop3:0x78
    ds_add_u32 v92, v4 offset:0
    v_mul_hi_u32_u24 v19, 0x92cc4, v89
    v_mul_hi_u32_u24 v20, 0xa7c5b, v93
    v_mul_u32_u24 v21, 4682, v19
    v_mad_i32_i24 v89, v19, s54, v89
    v_mad_i32_i24 v93, v20, s51, v93
    v_lshrrev_b32 v21, 16, v21
    v_lshl_or_b32 v89, v93, 13, v89
    v_lshl_add_u32 v93, v20, 4, v19
    v_mad_u32_u24 v93, v21, s55, v93
    v_bfe_i32 v20, v20, 0, 1
    v_add_lshl_u32 v93, v93, 2, 2
    v_bitop3_b32 v93, v93, v20, 60 bitop3:0x78
    ds_add_u32 v93, v4 offset:0
    v_mul_hi_u32_u24 v19, 0x92cc4, v90
    v_mul_hi_u32_u24 v20, 0xa7c5b, v94
    v_mul_u32_u24 v21, 4682, v19
    v_mad_i32_i24 v90, v19, s54, v90
    v_mad_i32_i24 v94, v20, s51, v94
    v_lshrrev_b32 v21, 16, v21
    v_lshl_or_b32 v90, v94, 13, v90
    v_lshl_add_u32 v94, v20, 4, v19
    v_mad_u32_u24 v94, v21, s55, v94
    v_bfe_i32 v20, v20, 0, 1
    v_add_lshl_u32 v94, v94, 2, 2
    v_bitop3_b32 v94, v94, v20, 60 bitop3:0x78
    ds_add_u32 v94, v4 offset:0
    v_mul_hi_u32_u24 v19, 0x92cc4, v91
    v_mul_hi_u32_u24 v20, 0xa7c5b, v95
    v_mul_u32_u24 v21, 4682, v19
    v_mad_i32_i24 v91, v19, s54, v91
    v_mad_i32_i24 v95, v20, s51, v95
    v_lshrrev_b32 v21, 16, v21
    v_lshl_or_b32 v91, v95, 13, v91
    v_lshl_add_u32 v95, v20, 4, v19
    v_mad_u32_u24 v95, v21, s55, v95
    v_bfe_i32 v20, v20, 0, 1
    v_add_lshl_u32 v95, v95, 2, 2
    v_bitop3_b32 v95, v95, v20, 60 bitop3:0x78
    ds_add_u32 v95, v4 offset:0
    s_cmp_eq_u32 s36, 0x3f800000
    s_cbranch_scc1 P_NF_9
    v_lshlrev_b32 v22, 16, v96
    v_and_b32 v23, s49, v96
    v_mul_f32 v22, s36, v22
    v_mul_f32 v23, s36, v23
    v_cvt_pk_bf16_f32 v96, v22, v23
    v_lshlrev_b32 v22, 16, v97
    v_and_b32 v23, s49, v97
    v_mul_f32 v22, s36, v22
    v_mul_f32 v23, s36, v23
    v_cvt_pk_bf16_f32 v97, v22, v23
P_NF_9:
    v_lshlrev_b32 v22, 16, v96
    v_and_b32 v23, s49, v96
    v_mul_f32 v19, s46, v22
    v_mul_f32 v20, s46, v23
    v_fract_f32 v19, v19
    v_fract_f32 v20, v20
    v_fmac_f32 v19, s47, v22
    v_fmac_f32 v20, s47, v23
    v_cos_f32 v22, v19
    v_cos_f32 v23, v20
    s_nop 0
    v_cvt_pk_bf16_f32 v96, v22, v23
    v_lshlrev_b32 v22, 16, v96
    v_and_b32 v23, s49, v96
    v_cvt_pk_f16_f32 v96, v22, v23
    v_lshlrev_b32 v22, 16, v96
    v_and_or_b32 v89, v96, s48, v89
    v_and_or_b32 v88, v22, s48, v88
    v_lshrrev_b32 v96, 2, v96
    v_lshlrev_b32 v22, 16, v97
    v_and_b32 v23, s49, v97
    v_mul_f32 v19, s46, v22
    v_mul_f32 v20, s46, v23
    v_fract_f32 v19, v19
    v_fract_f32 v20, v20
    v_fmac_f32 v19, s47, v22
    v_fmac_f32 v20, s47, v23
    v_cos_f32 v22, v19
    v_cos_f32 v23, v20
    s_nop 0
    v_cvt_pk_bf16_f32 v97, v22, v23
    v_lshlrev_b32 v22, 16, v97
    v_and_b32 v23, s49, v97
    v_cvt_pk_f16_f32 v97, v22, v23
    v_lshlrev_b32 v22, 16, v97
    v_and_or_b32 v91, v97, s48, v91
    v_and_or_b32 v90, v22, s48, v90
    v_lshrrev_b32 v97, 2, v97
    ds_add_rtn_u32 v8, v68, v3 offset:0
    ds_add_rtn_u32 v9, v69, v3 offset:0
    ds_add_rtn_u32 v10, v70, v3 offset:0
    ds_add_rtn_u32 v11, v71, v3 offset:0
    s_waitcnt lgkmcnt(8)
    s_add_u32 s43, s37, 25169920
    s_add_u32 s44, s38, 12584960
    buffer_load_dwordx4 v[28:31], v1, s[20:23], s43 offen nt
    buffer_load_dwordx4 v[24:27], v1, s[16:19], s43 offen nt
    buffer_load_dwordx2 v[32:33], v2, s[24:27], s44 offen nt
    v_and_b32 v12, 0xffff, v12
    v_mul_hi_u32 v16, v12, s53
    v_lshlrev_b32 v17, 2, v12
    v_add_u32 v12, v16, v12
    ds_write_b32 v17, v54 offset:49984
    ds_write_b8 v12, v62 offset:16640
    v_and_b32 v13, 0xffff, v13
    v_mul_hi_u32 v16, v13, s53
    v_lshlrev_b32 v18, 2, v13
    v_add_u32 v13, v16, v13
    ds_write_b32 v18, v55 offset:49984
    ds_write_b8_d16_hi v13, v62 offset:16640
    v_and_b32 v14, 0xffff, v14
    v_mul_hi_u32 v16, v14, s53
    v_lshlrev_b32 v17, 2, v14
    v_add_u32 v14, v16, v14
    ds_write_b32 v17, v56 offset:49984
    ds_write_b8 v14, v63 offset:16640
    v_and_b32 v15, 0xffff, v15
    v_mul_hi_u32 v16, v15, s53
    v_lshlrev_b32 v18, 2, v15
    v_add_u32 v15, v16, v15
    ds_write_b32 v18, v57 offset:49984
    ds_write_b8_d16_hi v15, v63 offset:16640
    s_waitcnt vmcnt(9)
    v_mul_hi_u32_u24 v19, 0x92cc4, v98
    v_mul_hi_u32_u24 v20, 0xa7c5b, v102
    v_mul_u32_u24 v21, 4682, v19
    v_mad_i32_i24 v98, v19, s54, v98
    v_mad_i32_i24 v102, v20, s51, v102
    v_lshrrev_b32 v21, 16, v21
    v_lshl_or_b32 v98, v102, 13, v98
    v_lshl_add_u32 v102, v20, 4, v19
    v_mad_u32_u24 v102, v21, s55, v102
    v_bfe_i32 v20, v20, 0, 1
    v_add_lshl_u32 v102, v102, 2, 2
    v_bitop3_b32 v102, v102, v20, 60 bitop3:0x78
    ds_add_u32 v102, v4 offset:0
    v_mul_hi_u32_u24 v19, 0x92cc4, v99
    v_mul_hi_u32_u24 v20, 0xa7c5b, v103
    v_mul_u32_u24 v21, 4682, v19
    v_mad_i32_i24 v99, v19, s54, v99
    v_mad_i32_i24 v103, v20, s51, v103
    v_lshrrev_b32 v21, 16, v21
    v_lshl_or_b32 v99, v103, 13, v99
    v_lshl_add_u32 v103, v20, 4, v19
    v_mad_u32_u24 v103, v21, s55, v103
    v_bfe_i32 v20, v20, 0, 1
    v_add_lshl_u32 v103, v103, 2, 2
    v_bitop3_b32 v103, v103, v20, 60 bitop3:0x78
    ds_add_u32 v103, v4 offset:0
    v_mul_hi_u32_u24 v19, 0x92cc4, v100
    v_mul_hi_u32_u24 v20, 0xa7c5b, v104
    v_mul_u32_u24 v21, 4682, v19
    v_mad_i32_i24 v100, v19, s54, v100
    v_mad_i32_i24 v104, v20, s51, v104
    v_lshrrev_b32 v21, 16, v21
    v_lshl_or_b32 v100, v104, 13, v100
    v_lshl_add_u32 v104, v20, 4, v19
    v_mad_u32_u24 v104, v21, s55, v104
    v_bfe_i32 v20, v20, 0, 1
    v_add_lshl_u32 v104, v104, 2, 2
    v_bitop3_b32 v104, v104, v20, 60 bitop3:0x78
    ds_add_u32 v104, v4 offset:0
    v_mul_hi_u32_u24 v19, 0x92cc4, v101
    v_mul_hi_u32_u24 v20, 0xa7c5b, v105
    v_mul_u32_u24 v21, 4682, v19
    v_mad_i32_i24 v101, v19, s54, v101
    v_mad_i32_i24 v105, v20, s51, v105
    v_lshrrev_b32 v21, 16, v21
    v_lshl_or_b32 v101, v105, 13, v101
    v_lshl_add_u32 v105, v20, 4, v19
    v_mad_u32_u24 v105, v21, s55, v105
    v_bfe_i32 v20, v20, 0, 1
    v_add_lshl_u32 v105, v105, 2, 2
    v_bitop3_b32 v105, v105, v20, 60 bitop3:0x78
    ds_add_u32 v105, v4 offset:0
    s_cmp_eq_u32 s36, 0x3f800000
    s_cbranch_scc1 P_NF_10
    v_lshlrev_b32 v22, 16, v106
    v_and_b32 v23, s49, v106
    v_mul_f32 v22, s36, v22
    v_mul_f32 v23, s36, v23
    v_cvt_pk_bf16_f32 v106, v22, v23
    v_lshlrev_b32 v22, 16, v107
    v_and_b32 v23, s49, v107
    v_mul_f32 v22, s36, v22
    v_mul_f32 v23, s36, v23
    v_cvt_pk_bf16_f32 v107, v22, v23
P_NF_10:
    v_lshlrev_b32 v22, 16, v106
    v_and_b32 v23, s49, v106
    v_mul_f32 v19, s46, v22
    v_mul_f32 v20, s46, v23
    v_fract_f32 v19, v19
    v_fract_f32 v20, v20
    v_fmac_f32 v19, s47, v22
    v_fmac_f32 v20, s47, v23
    v_cos_f32 v22, v19
    v_cos_f32 v23, v20
    s_nop 0
    v_cvt_pk_bf16_f32 v106, v22, v23
    v_lshlrev_b32 v22, 16, v106
    v_and_b32 v23, s49, v106
    v_cvt_pk_f16_f32 v106, v22, v23
    v_lshlrev_b32 v22, 16, v106
    v_and_or_b32 v99, v106, s48, v99
    v_and_or_b32 v98, v22, s48, v98
    v_lshrrev_b32 v106, 2, v106
    v_lshlrev_b32 v22, 16, v107
    v_and_b32 v23, s49, v107
    v_mul_f32 v19, s46, v22
    v_mul_f32 v20, s46, v23
    v_fract_f32 v19, v19
    v_fract_f32 v20, v20
    v_fmac_f32 v19, s47, v22
    v_fmac_f32 v20, s47, v23
    v_cos_f32 v22, v19
    v_cos_f32 v23, v20
    s_nop 0
    v_cvt_pk_bf16_f32 v107, v22, v23
    v_lshlrev_b32 v22, 16, v107
    v_and_b32 v23, s49, v107
    v_cvt_pk_f16_f32 v107, v22, v23
    v_lshlrev_b32 v22, 16, v107
    v_and_or_b32 v101, v107, s48, v101
    v_and_or_b32 v100, v22, s48, v100
    v_lshrrev_b32 v107, 2, v107
    ds_add_rtn_u32 v12, v78, v3 offset:0
    ds_add_rtn_u32 v13, v79, v3 offset:0
    ds_add_rtn_u32 v14, v80, v3 offset:0
    ds_add_rtn_u32 v15, v81, v3 offset:0
    s_waitcnt lgkmcnt(8)
    s_add_u32 s43, s37, 25170944
    s_add_u32 s44, s38, 12585472
    buffer_load_dwordx4 v[38:41], v1, s[20:23], s43 offen nt
    buffer_load_dwordx4 v[34:37], v1, s[16:19], s43 offen nt
    buffer_load_dwordx2 v[42:43], v2, s[24:27], s44 offen nt
    v_and_b32 v8, 0xffff, v8
    v_mul_hi_u32 v16, v8, s53
    v_lshlrev_b32 v17, 2, v8
    v_add_u32 v8, v16, v8
    ds_write_b32 v17, v64 offset:49984
    ds_write_b8 v8, v72 offset:16640
    v_and_b32 v9, 0xffff, v9
    v_mul_hi_u32 v16, v9, s53
    v_lshlrev_b32 v18, 2, v9
    v_add_u32 v9, v16, v9
    ds_write_b32 v18, v65 offset:49984
    ds_write_b8_d16_hi v9, v72 offset:16640
    v_and_b32 v10, 0xffff, v10
    v_mul_hi_u32 v16, v10, s53
    v_lshlrev_b32 v17, 2, v10
    v_add_u32 v10, v16, v10
    ds_write_b32 v17, v66 offset:49984
    ds_write_b8 v10, v73 offset:16640
    v_and_b32 v11, 0xffff, v11
    v_mul_hi_u32 v16, v11, s53
    v_lshlrev_b32 v18, 2, v11
    v_add_u32 v11, v16, v11
    ds_write_b32 v18, v67 offset:49984
    ds_write_b8_d16_hi v11, v73 offset:16640
    s_waitcnt vmcnt(9)
    v_mul_hi_u32_u24 v19, 0x92cc4, v108
    v_mul_hi_u32_u24 v20, 0xa7c5b, v112
    v_mul_u32_u24 v21, 4682, v19
    v_mad_i32_i24 v108, v19, s54, v108
    v_mad_i32_i24 v112, v20, s51, v112
    v_lshrrev_b32 v21, 16, v21
    v_lshl_or_b32 v108, v112, 13, v108
    v_lshl_add_u32 v112, v20, 4, v19
    v_mad_u32_u24 v112, v21, s55, v112
    v_bfe_i32 v20, v20, 0, 1
    v_add_lshl_u32 v112, v112, 2, 2
    v_bitop3_b32 v112, v112, v20, 60 bitop3:0x78
    ds_add_u32 v112, v4 offset:0
    v_mul_hi_u32_u24 v19, 0x92cc4, v109
    v_mul_hi_u32_u24 v20, 0xa7c5b, v113
    v_mul_u32_u24 v21, 4682, v19
    v_mad_i32_i24 v109, v19, s54, v109
    v_mad_i32_i24 v113, v20, s51, v113
    v_lshrrev_b32 v21, 16, v21
    v_lshl_or_b32 v109, v113, 13, v109
    v_lshl_add_u32 v113, v20, 4, v19
    v_mad_u32_u24 v113, v21, s55, v113
    v_bfe_i32 v20, v20, 0, 1
    v_add_lshl_u32 v113, v113, 2, 2
    v_bitop3_b32 v113, v113, v20, 60 bitop3:0x78
    ds_add_u32 v113, v4 offset:0
    v_mul_hi_u32_u24 v19, 0x92cc4, v110
    v_mul_hi_u32_u24 v20, 0xa7c5b, v114
    v_mul_u32_u24 v21, 4682, v19
    v_mad_i32_i24 v110, v19, s54, v110
    v_mad_i32_i24 v114, v20, s51, v114
    v_lshrrev_b32 v21, 16, v21
    v_lshl_or_b32 v110, v114, 13, v110
    v_lshl_add_u32 v114, v20, 4, v19
    v_mad_u32_u24 v114, v21, s55, v114
    v_bfe_i32 v20, v20, 0, 1
    v_add_lshl_u32 v114, v114, 2, 2
    v_bitop3_b32 v114, v114, v20, 60 bitop3:0x78
    ds_add_u32 v114, v4 offset:0
    v_mul_hi_u32_u24 v19, 0x92cc4, v111
    v_mul_hi_u32_u24 v20, 0xa7c5b, v115
    v_mul_u32_u24 v21, 4682, v19
    v_mad_i32_i24 v111, v19, s54, v111
    v_mad_i32_i24 v115, v20, s51, v115
    v_lshrrev_b32 v21, 16, v21
    v_lshl_or_b32 v111, v115, 13, v111
    v_lshl_add_u32 v115, v20, 4, v19
    v_mad_u32_u24 v115, v21, s55, v115
    v_bfe_i32 v20, v20, 0, 1
    v_add_lshl_u32 v115, v115, 2, 2
    v_bitop3_b32 v115, v115, v20, 60 bitop3:0x78
    ds_add_u32 v115, v4 offset:0
    s_cmp_eq_u32 s36, 0x3f800000
    s_cbranch_scc1 P_NF_11
    v_lshlrev_b32 v22, 16, v116
    v_and_b32 v23, s49, v116
    v_mul_f32 v22, s36, v22
    v_mul_f32 v23, s36, v23
    v_cvt_pk_bf16_f32 v116, v22, v23
    v_lshlrev_b32 v22, 16, v117
    v_and_b32 v23, s49, v117
    v_mul_f32 v22, s36, v22
    v_mul_f32 v23, s36, v23
    v_cvt_pk_bf16_f32 v117, v22, v23
P_NF_11:
    v_lshlrev_b32 v22, 16, v116
    v_and_b32 v23, s49, v116
    v_mul_f32 v19, s46, v22
    v_mul_f32 v20, s46, v23
    v_fract_f32 v19, v19
    v_fract_f32 v20, v20
    v_fmac_f32 v19, s47, v22
    v_fmac_f32 v20, s47, v23
    v_cos_f32 v22, v19
    v_cos_f32 v23, v20
    s_nop 0
    v_cvt_pk_bf16_f32 v116, v22, v23
    v_lshlrev_b32 v22, 16, v116
    v_and_b32 v23, s49, v116
    v_cvt_pk_f16_f32 v116, v22, v23
    v_lshlrev_b32 v22, 16, v116
    v_and_or_b32 v109, v116, s48, v109
    v_and_or_b32 v108, v22, s48, v108
    v_lshrrev_b32 v116, 2, v116
    v_lshlrev_b32 v22, 16, v117
    v_and_b32 v23, s49, v117
    v_mul_f32 v19, s46, v22
    v_mul_f32 v20, s46, v23
    v_fract_f32 v19, v19
    v_fract_f32 v20, v20
    v_fmac_f32 v19, s47, v22
    v_fmac_f32 v20, s47, v23
    v_cos_f32 v22, v19
    v_cos_f32 v23, v20
    s_nop 0
    v_cvt_pk_bf16_f32 v117, v22, v23
    v_lshlrev_b32 v22, 16, v117
    v_and_b32 v23, s49, v117
    v_cvt_pk_f16_f32 v117, v22, v23
    v_lshlrev_b32 v22, 16, v117
    v_and_or_b32 v111, v117, s48, v111
    v_and_or_b32 v110, v22, s48, v110
    v_lshrrev_b32 v117, 2, v117
    s_mov_b64 exec, s[40:41]
    ds_add_rtn_u32 v8, v85, v3 offset:0
    s_mov_b64 exec, -1
    s_waitcnt lgkmcnt(4)
    s_add_u32 s43, s68, 50765824
    s_add_u32 s44, s69, 25382912
    s_or_b64 exec, s[40:41], 1
    buffer_load_dword v45, v6, s[20:23], s43 offen nt
    buffer_load_dword v44, v6, s[16:19], s43 offen nt
    buffer_load_ushort v46, v7, s[24:27], s44 offen nt
    s_mov_b64 exec, -1
    v_and_b32 v12, 0xffff, v12
    v_mul_hi_u32 v16, v12, s53
    v_lshlrev_b32 v17, 2, v12
    v_add_u32 v12, v16, v12
    ds_write_b32 v17, v74 offset:49984
    ds_write_b8 v12, v82 offset:16640
    v_and_b32 v13, 0xffff, v13
    v_mul_hi_u32 v16, v13, s53
    v_lshlrev_b32 v18, 2, v13
    v_add_u32 v13, v16, v13
    ds_write_b32 v18, v75 offset:49984
    ds_write_b8_d16_hi v13, v82 offset:16640
    v_and_b32 v14, 0xffff, v14
    v_mul_hi_u32 v16, v14, s53
    v_lshlrev_b32 v17, 2, v14
    v_add_u32 v14, v16, v14
    ds_write_b32 v17, v76 offset:49984
    ds_write_b8 v14, v83 offset:16640
    v_and_b32 v15, 0xffff, v15
    v_mul_hi_u32 v16, v15, s53
    v_lshlrev_b32 v18, 2, v15
    v_add_u32 v15, v16, v15
    ds_write_b32 v18, v77 offset:49984
    ds_write_b8_d16_hi v15, v83 offset:16640
    s_waitcnt vmcnt(9)
    v_mul_hi_u32_u24 v19, 0x92cc4, v118
    v_mul_hi_u32_u24 v20, 0xa7c5b, v122
    v_mul_u32_u24 v21, 4682, v19
    v_mad_i32_i24 v118, v19, s54, v118
    v_mad_i32_i24 v122, v20, s51, v122
    v_lshrrev_b32 v21, 16, v21
    v_lshl_or_b32 v118, v122, 13, v118
    v_lshl_add_u32 v122, v20, 4, v19
    v_mad_u32_u24 v122, v21, s55, v122
    v_bfe_i32 v20, v20, 0, 1
    v_add_lshl_u32 v122, v122, 2, 2
    v_bitop3_b32 v122, v122, v20, 60 bitop3:0x78
    ds_add_u32 v122, v4 offset:0
    v_mul_hi_u32_u24 v19, 0x92cc4, v119
    v_mul_hi_u32_u24 v20, 0xa7c5b, v123
    v_mul_u32_u24 v21, 4682, v19
    v_mad_i32_i24 v119, v19, s54, v119
    v_mad_i32_i24 v123, v20, s51, v123
    v_lshrrev_b32 v21, 16, v21
    v_lshl_or_b32 v119, v123, 13, v119
    v_lshl_add_u32 v123, v20, 4, v19
    v_mad_u32_u24 v123, v21, s55, v123
    v_bfe_i32 v20, v20, 0, 1
    v_add_lshl_u32 v123, v123, 2, 2
    v_bitop3_b32 v123, v123, v20, 60 bitop3:0x78
    ds_add_u32 v123, v4 offset:0
    v_mul_hi_u32_u24 v19, 0x92cc4, v120
    v_mul_hi_u32_u24 v20, 0xa7c5b, v124
    v_mul_u32_u24 v21, 4682, v19
    v_mad_i32_i24 v120, v19, s54, v120
    v_mad_i32_i24 v124, v20, s51, v124
    v_lshrrev_b32 v21, 16, v21
    v_lshl_or_b32 v120, v124, 13, v120
    v_lshl_add_u32 v124, v20, 4, v19
    v_mad_u32_u24 v124, v21, s55, v124
    v_bfe_i32 v20, v20, 0, 1
    v_add_lshl_u32 v124, v124, 2, 2
    v_bitop3_b32 v124, v124, v20, 60 bitop3:0x78
    ds_add_u32 v124, v4 offset:0
    v_mul_hi_u32_u24 v19, 0x92cc4, v121
    v_mul_hi_u32_u24 v20, 0xa7c5b, v125
    v_mul_u32_u24 v21, 4682, v19
    v_mad_i32_i24 v121, v19, s54, v121
    v_mad_i32_i24 v125, v20, s51, v125
    v_lshrrev_b32 v21, 16, v21
    v_lshl_or_b32 v121, v125, 13, v121
    v_lshl_add_u32 v125, v20, 4, v19
    v_mad_u32_u24 v125, v21, s55, v125
    v_bfe_i32 v20, v20, 0, 1
    v_add_lshl_u32 v125, v125, 2, 2
    v_bitop3_b32 v125, v125, v20, 60 bitop3:0x78
    ds_add_u32 v125, v4 offset:0
    s_cmp_eq_u32 s36, 0x3f800000
    s_cbranch_scc1 P_NF_12
    v_lshlrev_b32 v22, 16, v126
    v_and_b32 v23, s49, v126
    v_mul_f32 v22, s36, v22
    v_mul_f32 v23, s36, v23
    v_cvt_pk_bf16_f32 v126, v22, v23
    v_lshlrev_b32 v22, 16, v127
    v_and_b32 v23, s49, v127
    v_mul_f32 v22, s36, v22
    v_mul_f32 v23, s36, v23
    v_cvt_pk_bf16_f32 v127, v22, v23
P_NF_12:
    v_lshlrev_b32 v22, 16, v126
    v_and_b32 v23, s49, v126
    v_mul_f32 v19, s46, v22
    v_mul_f32 v20, s46, v23
    v_fract_f32 v19, v19
    v_fract_f32 v20, v20
    v_fmac_f32 v19, s47, v22
    v_fmac_f32 v20, s47, v23
    v_cos_f32 v22, v19
    v_cos_f32 v23, v20
    s_nop 0
    v_cvt_pk_bf16_f32 v126, v22, v23
    v_lshlrev_b32 v22, 16, v126
    v_and_b32 v23, s49, v126
    v_cvt_pk_f16_f32 v126, v22, v23
    v_lshlrev_b32 v22, 16, v126
    v_and_or_b32 v119, v126, s48, v119
    v_and_or_b32 v118, v22, s48, v118
    v_lshrrev_b32 v126, 2, v126
    v_lshlrev_b32 v22, 16, v127
    v_and_b32 v23, s49, v127
    v_mul_f32 v19, s46, v22
    v_mul_f32 v20, s46, v23
    v_fract_f32 v19, v19
    v_fract_f32 v20, v20
    v_fmac_f32 v19, s47, v22
    v_fmac_f32 v20, s47, v23
    v_cos_f32 v22, v19
    v_cos_f32 v23, v20
    s_nop 0
    v_cvt_pk_bf16_f32 v127, v22, v23
    v_lshlrev_b32 v22, 16, v127
    v_and_b32 v23, s49, v127
    v_cvt_pk_f16_f32 v127, v22, v23
    v_lshlrev_b32 v22, 16, v127
    v_and_or_b32 v121, v127, s48, v121
    v_and_or_b32 v120, v22, s48, v120
    v_lshrrev_b32 v127, 2, v127
    s_waitcnt lgkmcnt(4)
    s_mov_b64 exec, s[40:41]
    v_and_b32 v8, 0xffff, v8
    v_mul_hi_u32 v16, v8, s53
    v_lshlrev_b32 v17, 2, v8
    v_add_u32 v8, v16, v8
    ds_write_b32 v17, v84 offset:49984
    ds_write_b8 v8, v86 offset:16640
    s_mov_b64 exec, -1
    s_waitcnt lgkmcnt(0)
    s_barrier
    v_and_b32 v47, 0xfc, v6
    buffer_load_dword v84, v47, s[32:35], s39 offen offset:0
    buffer_load_dword v85, v47, s[32:35], s39 offen offset:256
    buffer_load_dword v86, v47, s[32:35], s39 offen offset:512
    buffer_load_dword v87, v47, s[32:35], s39 offen offset:768
    s_movk_i32 s42, 142
    v_cmp_gt_u32 s[64:65], s42, v0
    v_mul_u32_u24 v8, 12, v0
    v_add_u32 v8, 49984, v8
    s_mul_i32 s66, s2, 266752
    ds_read2_b32 v[48:49], v8 offset0:0 offset1:1
    ds_read_b32 v50, v8 offset:8
    ds_read_b32 v51, v6 offset:16640
    v_add_u32 v8, 12288, v8
    ds_read2_b32 v[52:53], v8 offset0:0 offset1:1
    ds_read_b32 v54, v8 offset:8
    ds_read_b32 v55, v6 offset:20736
    v_add_u32 v8, 12288, v8
    ds_read2_b32 v[56:57], v8 offset0:0 offset1:1
    ds_read_b32 v58, v8 offset:8
    ds_read_b32 v59, v6 offset:24832
    v_add_u32 v8, 12288, v8
    ds_read2_b32 v[60:61], v8 offset0:0 offset1:1
    ds_read_b32 v62, v8 offset:8
    ds_read_b32 v63, v6 offset:28928
    v_add_u32 v8, 12288, v8
    ds_read2_b32 v[64:65], v8 offset0:0 offset1:1
    ds_read_b32 v66, v8 offset:8
    ds_read_b32 v67, v6 offset:33024
    v_add_u32 v8, 12288, v8
    ds_read2_b32 v[68:69], v8 offset0:0 offset1:1
    ds_read_b32 v70, v8 offset:8
    ds_read_b32 v71, v6 offset:37120
    v_add_u32 v8, 12288, v8
    ds_read2_b32 v[72:73], v8 offset0:0 offset1:1
    ds_read_b32 v74, v8 offset:8
    ds_read_b32 v75, v6 offset:41216
    v_add_u32 v8, 12288, v8
    ds_read2_b32 v[76:77], v8 offset0:0 offset1:1
    ds_read_b32 v78, v8 offset:8
    ds_read_b32 v79, v6 offset:45312
    v_add_u32 v8, 12288, v8
    s_mov_b64 exec, s[64:65]
    ds_read2_b32 v[80:81], v8 offset0:0 offset1:1
    ds_read_b32 v82, v8 offset:8
    ds_read_b32 v83, v6 offset:49408
    s_mov_b64 exec, -1
    s_waitcnt vmcnt(10)
    v_mul_hi_u32_u24 v19, 0x92cc4, v24
    v_mul_hi_u32_u24 v20, 0xa7c5b, v28
    v_mul_u32_u24 v21, 4682, v19
    v_mad_i32_i24 v24, v19, s54, v24
    v_mad_i32_i24 v28, v20, s51, v28
    v_lshrrev_b32 v21, 16, v21
    v_lshl_or_b32 v24, v28, 13, v24
    v_lshl_add_u32 v28, v20, 4, v19
    v_mad_u32_u24 v28, v21, s55, v28
    v_bfe_i32 v20, v20, 0, 1
    v_add_lshl_u32 v28, v28, 2, 2
    v_bitop3_b32 v28, v28, v20, 60 bitop3:0x78
    ds_add_u32 v28, v4 offset:0
    v_mul_hi_u32_u24 v19, 0x92cc4, v25
    v_mul_hi_u32_u24 v20, 0xa7c5b, v29
    v_mul_u32_u24 v21, 4682, v19
    v_mad_i32_i24 v25, v19, s54, v25
    v_mad_i32_i24 v29, v20, s51, v29
    v_lshrrev_b32 v21, 16, v21
    v_lshl_or_b32 v25, v29, 13, v25
    v_lshl_add_u32 v29, v20, 4, v19
    v_mad_u32_u24 v29, v21, s55, v29
    v_bfe_i32 v20, v20, 0, 1
    v_add_lshl_u32 v29, v29, 2, 2
    v_bitop3_b32 v29, v29, v20, 60 bitop3:0x78
    ds_add_u32 v29, v4 offset:0
    v_mul_hi_u32_u24 v19, 0x92cc4, v26
    v_mul_hi_u32_u24 v20, 0xa7c5b, v30
    v_mul_u32_u24 v21, 4682, v19
    v_mad_i32_i24 v26, v19, s54, v26
    v_mad_i32_i24 v30, v20, s51, v30
    v_lshrrev_b32 v21, 16, v21
    v_lshl_or_b32 v26, v30, 13, v26
    v_lshl_add_u32 v30, v20, 4, v19
    v_mad_u32_u24 v30, v21, s55, v30
    v_bfe_i32 v20, v20, 0, 1
    v_add_lshl_u32 v30, v30, 2, 2
    v_bitop3_b32 v30, v30, v20, 60 bitop3:0x78
    ds_add_u32 v30, v4 offset:0
    v_mul_hi_u32_u24 v19, 0x92cc4, v27
    v_mul_hi_u32_u24 v20, 0xa7c5b, v31
    v_mul_u32_u24 v21, 4682, v19
    v_mad_i32_i24 v27, v19, s54, v27
    v_mad_i32_i24 v31, v20, s51, v31
    v_lshrrev_b32 v21, 16, v21
    v_lshl_or_b32 v27, v31, 13, v27
    v_lshl_add_u32 v31, v20, 4, v19
    v_mad_u32_u24 v31, v21, s55, v31
    v_bfe_i32 v20, v20, 0, 1
    v_add_lshl_u32 v31, v31, 2, 2
    v_bitop3_b32 v31, v31, v20, 60 bitop3:0x78
    ds_add_u32 v31, v4 offset:0
    s_cmp_eq_u32 s36, 0x3f800000
    s_cbranch_scc1 P_NF_13
    v_lshlrev_b32 v22, 16, v32
    v_and_b32 v23, s49, v32
    v_mul_f32 v22, s36, v22
    v_mul_f32 v23, s36, v23
    v_cvt_pk_bf16_f32 v32, v22, v23
    v_lshlrev_b32 v22, 16, v33
    v_and_b32 v23, s49, v33
    v_mul_f32 v22, s36, v22
    v_mul_f32 v23, s36, v23
    v_cvt_pk_bf16_f32 v33, v22, v23
P_NF_13:
    v_lshlrev_b32 v22, 16, v32
    v_and_b32 v23, s49, v32
    v_mul_f32 v19, s46, v22
    v_mul_f32 v20, s46, v23
    v_fract_f32 v19, v19
    v_fract_f32 v20, v20
    v_fmac_f32 v19, s47, v22
    v_fmac_f32 v20, s47, v23
    v_cos_f32 v22, v19
    v_cos_f32 v23, v20
    s_nop 0
    v_cvt_pk_bf16_f32 v32, v22, v23
    v_lshlrev_b32 v22, 16, v32
    v_and_b32 v23, s49, v32
    v_cvt_pk_f16_f32 v32, v22, v23
    v_lshlrev_b32 v22, 16, v32
    v_and_or_b32 v25, v32, s48, v25
    v_and_or_b32 v24, v22, s48, v24
    v_lshrrev_b32 v32, 2, v32
    v_lshlrev_b32 v22, 16, v33
    v_and_b32 v23, s49, v33
    v_mul_f32 v19, s46, v22
    v_mul_f32 v20, s46, v23
    v_fract_f32 v19, v19
    v_fract_f32 v20, v20
    v_fmac_f32 v19, s47, v22
    v_fmac_f32 v20, s47, v23
    v_cos_f32 v22, v19
    v_cos_f32 v23, v20
    s_nop 0
    v_cvt_pk_bf16_f32 v33, v22, v23
    v_lshlrev_b32 v22, 16, v33
    v_and_b32 v23, s49, v33
    v_cvt_pk_f16_f32 v33, v22, v23
    v_lshlrev_b32 v22, 16, v33
    v_and_or_b32 v27, v33, s48, v27
    v_and_or_b32 v26, v22, s48, v26
    v_lshrrev_b32 v33, 2, v33
    s_waitcnt lgkmcnt(0)
    s_waitcnt vmcnt(7)
    v_mul_hi_u32_u24 v19, 0x92cc4, v34
    v_mul_hi_u32_u24 v20, 0xa7c5b, v38
    v_mul_u32_u24 v21, 4682, v19
    v_mad_i32_i24 v34, v19, s54, v34
    v_mad_i32_i24 v38, v20, s51, v38
    v_lshrrev_b32 v21, 16, v21
    v_lshl_or_b32 v34, v38, 13, v34
    v_lshl_add_u32 v38, v20, 4, v19
    v_mad_u32_u24 v38, v21, s55, v38
    v_bfe_i32 v20, v20, 0, 1
    v_add_lshl_u32 v38, v38, 2, 2
    v_bitop3_b32 v38, v38, v20, 60 bitop3:0x78
    ds_add_u32 v38, v4 offset:0
    v_mul_hi_u32_u24 v19, 0x92cc4, v35
    v_mul_hi_u32_u24 v20, 0xa7c5b, v39
    v_mul_u32_u24 v21, 4682, v19
    v_mad_i32_i24 v35, v19, s54, v35
    v_mad_i32_i24 v39, v20, s51, v39
    v_lshrrev_b32 v21, 16, v21
    v_lshl_or_b32 v35, v39, 13, v35
    v_lshl_add_u32 v39, v20, 4, v19
    v_mad_u32_u24 v39, v21, s55, v39
    v_bfe_i32 v20, v20, 0, 1
    v_add_lshl_u32 v39, v39, 2, 2
    v_bitop3_b32 v39, v39, v20, 60 bitop3:0x78
    ds_add_u32 v39, v4 offset:0
    v_mul_hi_u32_u24 v19, 0x92cc4, v36
    v_mul_hi_u32_u24 v20, 0xa7c5b, v40
    v_mul_u32_u24 v21, 4682, v19
    v_mad_i32_i24 v36, v19, s54, v36
    v_mad_i32_i24 v40, v20, s51, v40
    v_lshrrev_b32 v21, 16, v21
    v_lshl_or_b32 v36, v40, 13, v36
    v_lshl_add_u32 v40, v20, 4, v19
    v_mad_u32_u24 v40, v21, s55, v40
    v_bfe_i32 v20, v20, 0, 1
    v_add_lshl_u32 v40, v40, 2, 2
    v_bitop3_b32 v40, v40, v20, 60 bitop3:0x78
    ds_add_u32 v40, v4 offset:0
    v_mul_hi_u32_u24 v19, 0x92cc4, v37
    v_mul_hi_u32_u24 v20, 0xa7c5b, v41
    v_mul_u32_u24 v21, 4682, v19
    v_mad_i32_i24 v37, v19, s54, v37
    v_mad_i32_i24 v41, v20, s51, v41
    v_lshrrev_b32 v21, 16, v21
    v_lshl_or_b32 v37, v41, 13, v37
    v_lshl_add_u32 v41, v20, 4, v19
    v_mad_u32_u24 v41, v21, s55, v41
    v_bfe_i32 v20, v20, 0, 1
    v_add_lshl_u32 v41, v41, 2, 2
    v_bitop3_b32 v41, v41, v20, 60 bitop3:0x78
    ds_add_u32 v41, v4 offset:0
    s_cmp_eq_u32 s36, 0x3f800000
    s_cbranch_scc1 P_NF_14
    v_lshlrev_b32 v22, 16, v42
    v_and_b32 v23, s49, v42
    v_mul_f32 v22, s36, v22
    v_mul_f32 v23, s36, v23
    v_cvt_pk_bf16_f32 v42, v22, v23
    v_lshlrev_b32 v22, 16, v43
    v_and_b32 v23, s49, v43
    v_mul_f32 v22, s36, v22
    v_mul_f32 v23, s36, v23
    v_cvt_pk_bf16_f32 v43, v22, v23
P_NF_14:
    v_lshlrev_b32 v22, 16, v42
    v_and_b32 v23, s49, v42
    v_mul_f32 v19, s46, v22
    v_mul_f32 v20, s46, v23
    v_fract_f32 v19, v19
    v_fract_f32 v20, v20
    v_fmac_f32 v19, s47, v22
    v_fmac_f32 v20, s47, v23
    v_cos_f32 v22, v19
    v_cos_f32 v23, v20
    s_nop 0
    v_cvt_pk_bf16_f32 v42, v22, v23
    v_lshlrev_b32 v22, 16, v42
    v_and_b32 v23, s49, v42
    v_cvt_pk_f16_f32 v42, v22, v23
    v_lshlrev_b32 v22, 16, v42
    v_and_or_b32 v35, v42, s48, v35
    v_and_or_b32 v34, v22, s48, v34
    v_lshrrev_b32 v42, 2, v42
    v_lshlrev_b32 v22, 16, v43
    v_and_b32 v23, s49, v43
    v_mul_f32 v19, s46, v22
    v_mul_f32 v20, s46, v23
    v_fract_f32 v19, v19
    v_fract_f32 v20, v20
    v_fmac_f32 v19, s47, v22
    v_fmac_f32 v20, s47, v23
    v_cos_f32 v22, v19
    v_cos_f32 v23, v20
    s_nop 0
    v_cvt_pk_bf16_f32 v43, v22, v23
    v_lshlrev_b32 v22, 16, v43
    v_and_b32 v23, s49, v43
    v_cvt_pk_f16_f32 v43, v22, v23
    v_lshlrev_b32 v22, 16, v43
    v_and_or_b32 v37, v43, s48, v37
    v_and_or_b32 v36, v22, s48, v36
    v_lshrrev_b32 v43, 2, v43
    s_waitcnt vmcnt(4)
    s_mov_b64 exec, s[40:41]
    s_cbranch_execz P_MS_15
    v_mul_hi_u32_u24 v19, 0x92cc4, v44
    v_mul_hi_u32_u24 v20, 0xa7c5b, v45
    v_mul_u32_u24 v21, 4682, v19
    v_mad_i32_i24 v44, v19, s54, v44
    v_mad_i32_i24 v45, v20, s51, v45
    v_lshrrev_b32 v21, 16, v21
    v_lshl_or_b32 v44, v45, 13, v44
    v_lshl_add_u32 v45, v20, 4, v19
    v_mad_u32_u24 v45, v21, s55, v45
    v_bfe_i32 v20, v20, 0, 1
    v_add_lshl_u32 v45, v45, 2, 2
    v_bitop3_b32 v45, v45, v20, 60 bitop3:0x78
    ds_add_u32 v45, v4 offset:0
    s_cmp_eq_u32 s36, 0x3f800000
    s_cbranch_scc1 P_NF_16
    v_lshlrev_b32 v22, 16, v46
    v_and_b32 v23, s49, v46
    v_mul_f32 v22, s36, v22
    v_mul_f32 v23, s36, v23
    v_cvt_pk_bf16_f32 v46, v22, v23
P_NF_16:
    v_lshlrev_b32 v22, 16, v46
    v_and_b32 v23, s49, v46
    v_mul_f32 v19, s46, v22
    v_mul_f32 v20, s46, v23
    v_fract_f32 v19, v19
    v_fract_f32 v20, v20
    v_fmac_f32 v19, s47, v22
    v_fmac_f32 v20, s47, v23
    v_cos_f32 v22, v19
    v_cos_f32 v23, v20
    s_nop 0
    v_cvt_pk_bf16_f32 v46, v22, v23
    v_lshlrev_b32 v22, 16, v46
    v_and_b32 v23, s49, v46
    v_cvt_pk_f16_f32 v46, v22, v23
    v_lshlrev_b32 v22, 16, v46
    v_and_or_b32 v44, v22, s48, v44
    v_lshrrev_b32 v46, 2, v46
P_MS_15:
    s_mov_b64 exec, -1
    s_waitcnt lgkmcnt(0)
    s_barrier
    ds_read_b128 v[8:11], v1 offset:0
    v_and_b32 v13, 63, v0
    v_cmp_lt_u32 vcc, s50, v13
    v_lshlrev_b32 v13, 2, v13
    s_and_b64 s[56:57], vcc, 0xffff
    s_waitcnt lgkmcnt(0)
    v_and_b32 v18, 0xffff, v8
    v_and_b32 v19, 0xffff, v9
    v_and_b32 v20, 0xffff, v10
    v_and_b32 v21, 0xffff, v11
    v_lshrrev_b32 v8, 16, v8
    v_lshrrev_b32 v9, 16, v9
    v_lshrrev_b32 v10, 16, v10
    v_lshrrev_b32 v11, 16, v11
    v_add_u32 v9, v8, v9
    v_add_u32 v10, v9, v10
    v_add_u32 v11, v10, v11
    v_mov_b32 v12, v11
    s_nop 1
    v_add_u32_dpp v12, v12, v12 row_shr:1 row_mask:0xf bank_mask:0xf bound_ctrl:0
    s_nop 1
    v_add_u32_dpp v12, v12, v12 row_shr:2 row_mask:0xf bank_mask:0xf bound_ctrl:0
    s_nop 1
    v_add_u32_dpp v12, v12, v12 row_shr:4 row_mask:0xf bank_mask:0xf bound_ctrl:0
    s_nop 1
    v_add_u32_dpp v12, v12, v12 row_shr:8 row_mask:0xf bank_mask:0xf bound_ctrl:0
    s_nop 1
    v_add_u32_dpp v12, v12, v12 row_bcast:15 row_mask:0xa bank_mask:0xf
    s_nop 1
    v_add_u32_dpp v12, v12, v12 row_bcast:31 row_mask:0xc bank_mask:0xf
    s_nop 1
    v_readlane_b32 s42, v12, 63
    s_nop 1
    v_mov_b32 v14, s42
    s_mov_b64 exec, s[56:57]
    ds_add_u32 v13, v14 offset:16448
    s_mov_b64 exec, -1
    s_lshl_b32 s42, s50, 2
    v_mov_b32 v13, s42
    v_sub_u32 v12, v12, v11
    v_mul_hi_u32 v16, v18, s53
    v_add_u32 v18, v16, v18
    v_mul_hi_u32 v16, v19, s53
    v_add_u32 v19, v16, v19
    v_mul_hi_u32 v16, v20, s53
    v_add_u32 v20, v16, v20
    v_mul_hi_u32 v16, v21, s53
    v_add_u32 v21, v16, v21
    v_lshl_or_b32 v16, v19, 16, v18
    v_lshl_or_b32 v17, v21, 16, v20
    v_mov_b32_dpp v23, v21 row_shr:1 row_mask:0xf bank_mask:0xf bound_ctrl:0
    v_and_b32 v22, -32, v2
    v_add_u32 v22, v22, v2
    s_mov_b32 exec_lo, 0xf0f0f0f0
    s_mov_b32 exec_hi, 0xf0f0f0f0
    v_lshl_or_b32 v16, v19, 16, v20
    v_lshl_or_b32 v17, v23, 16, v18
    v_sub_u32 v16, 0x823c823c, v16
    v_sub_u32 v17, 0x823c823c, v17
    v_xor_b32 v22, 24, v22
    s_mov_b64 exec, -1
    s_mul_i32 s42, s2, 16448
    s_add_u32 s42, s42, 0x4400000
    buffer_store_dwordx2 v[16:17], v22, s[28:31], s42 offen offset:64
    s_waitcnt lgkmcnt(0)
    s_barrier
    ds_read_b32 v13, v13 offset:16448
    ds_read_b64 v[14:15], v5 offset:16512
    s_waitcnt lgkmcnt(0)
    v_readfirstlane_b32 s71, v15
    v_add_u32 v12, v12, v13
    v_add_u32 v18, v12, v8
    v_add_u32 v19, v12, v9
    v_add_u32 v20, v12, v10
    v_add_u32 v21, v12, v11
    v_add_u32 v11, v12, v10
    v_add_u32 v10, v12, v9
    v_add_u32 v9, v12, v8
    v_mov_b32 v8, v12
    ds_write_b128 v1, v[8:11] offset:0
    s_lshr_b32 s71, s71, 7
    s_add_u32 s71, s71, 1
    v_mul_hi_u32 v16, v18, s53
    v_add_u32 v18, v16, v18
    v_mul_hi_u32 v16, v19, s53
    v_add_u32 v19, v16, v19
    v_mul_hi_u32 v16, v20, s53
    v_add_u32 v20, v16, v20
    v_mul_hi_u32 v16, v21, s53
    v_add_u32 v21, v16, v21
    v_lshl_or_b32 v16, v19, 16, v18
    v_lshl_or_b32 v17, v21, 16, v20
    v_mov_b32_dpp v23, v21 row_shr:1 row_mask:0xf bank_mask:0xf bound_ctrl:0
    s_mov_b32 exec_lo, 0xf0f0f0f0
    s_mov_b32 exec_hi, 0xf0f0f0f0
    v_lshl_or_b32 v16, v19, 16, v20
    v_lshl_or_b32 v17, v23, 16, v18
    v_sub_u32 v16, 0x823c823c, v16
    v_sub_u32 v17, 0x823c823c, v17
    s_mov_b64 exec, -1
    s_mul_i32 s42, s2, 16448
    s_add_u32 s42, s42, 0x4400000
    buffer_store_dwordx2 v[16:17], v22, s[28:31], s42 offen offset:96
    s_cmp_lg_u32 s50, 0
    s_cbranch_scc1 P_SC_17
    s_mov_b64 exec, 1
    s_lshl_b32 s42, s2, 2
    s_add_u32 s42, s42, 0x4c00400
    v_mov_b32 v13, s71
    buffer_store_dword v13, v5, s[28:31], s42 offen
    s_mov_b64 exec, -1
P_SC_17:
    s_waitcnt lgkmcnt(0)
    s_barrier
    ds_add_rtn_u32 v8, v92, v3 offset:0
    ds_add_rtn_u32 v9, v93, v3 offset:0
    ds_add_rtn_u32 v10, v94, v3 offset:0
    ds_add_rtn_u32 v11, v95, v3 offset:0
    ds_add_rtn_u32 v12, v102, v3 offset:0
    ds_add_rtn_u32 v13, v103, v3 offset:0
    ds_add_rtn_u32 v14, v104, v3 offset:0
    ds_add_rtn_u32 v15, v105, v3 offset:0
    s_waitcnt lgkmcnt(4)
    buffer_store_dwordx4 v[48:51], v1, s[28:31], s66 offen sc0 sc1
    s_add_u32 s66, s66, 16384
    buffer_store_dwordx4 v[52:55], v1, s[28:31], s66 offen sc0 sc1
    s_add_u32 s66, s66, 16384
    v_mul_hi_u32 v16, v8, s53
    v_lshlrev_b32 v17, 2, v8
    v_add_u32 v8, v16, v8
    ds_write_b32 v17, v88 offset:49984
    ds_write_b8 v8, v96 offset:16640
    v_mul_hi_u32 v16, v9, s53
    v_lshlrev_b32 v18, 2, v9
    v_add_u32 v9, v16, v9
    ds_write_b32 v18, v89 offset:49984
    ds_write_b8_d16_hi v9, v96 offset:16640
    v_mul_hi_u32 v16, v10, s53
    v_lshlrev_b32 v17, 2, v10
    v_add_u32 v10, v16, v10
    ds_write_b32 v17, v90 offset:49984
    ds_write_b8 v10, v97 offset:16640
    v_mul_hi_u32 v16, v11, s53
    v_lshlrev_b32 v18, 2, v11
    v_add_u32 v11, v16, v11
    ds_write_b32 v18, v91 offset:49984
    ds_write_b8_d16_hi v11, v97 offset:16640
    ds_add_rtn_u32 v8, v112, v3 offset:0
    ds_add_rtn_u32 v9, v113, v3 offset:0
    ds_add_rtn_u32 v10, v114, v3 offset:0
    ds_add_rtn_u32 v11, v115, v3 offset:0
    s_waitcnt lgkmcnt(4)
    buffer_store_dwordx4 v[56:59], v1, s[28:31], s66 offen sc0 sc1
    s_add_u32 s66, s66, 16384
    buffer_store_dwordx4 v[60:63], v1, s[28:31], s66 offen sc0 sc1
    s_add_u32 s66, s66, 16384
    v_mul_hi_u32 v16, v12, s53
    v_lshlrev_b32 v17, 2, v12
    v_add_u32 v12, v16, v12
    ds_write_b32 v17, v98 offset:49984
    ds_write_b8 v12, v106 offset:16640
    v_mul_hi_u32 v16, v13, s53
    v_lshlrev_b32 v18, 2, v13
    v_add_u32 v13, v16, v13
    ds_write_b32 v18, v99 offset:49984
    ds_write_b8_d16_hi v13, v106 offset:16640
    v_mul_hi_u32 v16, v14, s53
    v_lshlrev_b32 v17, 2, v14
    v_add_u32 v14, v16, v14
    ds_write_b32 v17, v100 offset:49984
    ds_write_b8 v14, v107 offset:16640
    v_mul_hi_u32 v16, v15, s53
    v_lshlrev_b32 v18, 2, v15
    v_add_u32 v15, v16, v15
    ds_write_b32 v18, v101 offset:49984
    ds_write_b8_d16_hi v15, v107 offset:16640
    ds_add_rtn_u32 v12, v122, v3 offset:0
    ds_add_rtn_u32 v13, v123, v3 offset:0
    ds_add_rtn_u32 v14, v124, v3 offset:0
    ds_add_rtn_u32 v15, v125, v3 offset:0
    s_waitcnt lgkmcnt(4)
    buffer_store_dwordx4 v[64:67], v1, s[28:31], s66 offen sc0 sc1
    s_add_u32 s66, s66, 16384
    v_mul_hi_u32 v16, v8, s53
    v_lshlrev_b32 v17, 2, v8
    v_add_u32 v8, v16, v8
    ds_write_b32 v17, v108 offset:49984
    ds_write_b8 v8, v116 offset:16640
    v_mul_hi_u32 v16, v9, s53
    v_lshlrev_b32 v18, 2, v9
    v_add_u32 v9, v16, v9
    ds_write_b32 v18, v109 offset:49984
    ds_write_b8_d16_hi v9, v116 offset:16640
    v_mul_hi_u32 v16, v10, s53
    v_lshlrev_b32 v17, 2, v10
    v_add_u32 v10, v16, v10
    ds_write_b32 v17, v110 offset:49984
    ds_write_b8 v10, v117 offset:16640
    v_mul_hi_u32 v16, v11, s53
    v_lshlrev_b32 v18, 2, v11
    v_add_u32 v11, v16, v11
    ds_write_b32 v18, v111 offset:49984
    ds_write_b8_d16_hi v11, v117 offset:16640
    ds_add_rtn_u32 v8, v28, v3 offset:0
    ds_add_rtn_u32 v9, v29, v3 offset:0
    ds_add_rtn_u32 v10, v30, v3 offset:0
    ds_add_rtn_u32 v11, v31, v3 offset:0
    s_waitcnt lgkmcnt(4)
    buffer_store_dwordx4 v[68:71], v1, s[28:31], s66 offen sc0 sc1
    s_add_u32 s66, s66, 16384
    v_mul_hi_u32 v16, v12, s53
    v_lshlrev_b32 v17, 2, v12
    v_add_u32 v12, v16, v12
    ds_write_b32 v17, v118 offset:49984
    ds_write_b8 v12, v126 offset:16640
    v_mul_hi_u32 v16, v13, s53
    v_lshlrev_b32 v18, 2, v13
    v_add_u32 v13, v16, v13
    ds_write_b32 v18, v119 offset:49984
    ds_write_b8_d16_hi v13, v126 offset:16640
    v_mul_hi_u32 v16, v14, s53
    v_lshlrev_b32 v17, 2, v14
    v_add_u32 v14, v16, v14
    ds_write_b32 v17, v120 offset:49984
    ds_write_b8 v14, v127 offset:16640
    v_mul_hi_u32 v16, v15, s53
    v_lshlrev_b32 v18, 2, v15
    v_add_u32 v15, v16, v15
    ds_write_b32 v18, v121 offset:49984
    ds_write_b8_d16_hi v15, v127 offset:16640
    ds_add_rtn_u32 v12, v38, v3 offset:0
    ds_add_rtn_u32 v13, v39, v3 offset:0
    ds_add_rtn_u32 v14, v40, v3 offset:0
    ds_add_rtn_u32 v15, v41, v3 offset:0
    s_waitcnt lgkmcnt(4)
    buffer_store_dwordx4 v[72:75], v1, s[28:31], s66 offen sc0 sc1
    s_add_u32 s66, s66, 16384
    v_mul_hi_u32 v16, v8, s53
    v_lshlrev_b32 v17, 2, v8
    v_add_u32 v8, v16, v8
    ds_write_b32 v17, v24 offset:49984
    ds_write_b8 v8, v32 offset:16640
    v_mul_hi_u32 v16, v9, s53
    v_lshlrev_b32 v18, 2, v9
    v_add_u32 v9, v16, v9
    ds_write_b32 v18, v25 offset:49984
    ds_write_b8_d16_hi v9, v32 offset:16640
    v_mul_hi_u32 v16, v10, s53
    v_lshlrev_b32 v17, 2, v10
    v_add_u32 v10, v16, v10
    ds_write_b32 v17, v26 offset:49984
    ds_write_b8 v10, v33 offset:16640
    v_mul_hi_u32 v16, v11, s53
    v_lshlrev_b32 v18, 2, v11
    v_add_u32 v11, v16, v11
    ds_write_b32 v18, v27 offset:49984
    ds_write_b8_d16_hi v11, v33 offset:16640
    s_mov_b64 exec, s[40:41]
    ds_add_rtn_u32 v8, v45, v3 offset:0
    s_mov_b64 exec, -1
    s_waitcnt lgkmcnt(0)
    buffer_store_dwordx4 v[76:79], v1, s[28:31], s66 offen sc0 sc1
    s_add_u32 s66, s66, 16384
    v_mul_hi_u32 v16, v12, s53
    v_lshlrev_b32 v17, 2, v12
    v_add_u32 v12, v16, v12
    ds_write_b32 v17, v34 offset:49984
    ds_write_b8 v12, v42 offset:16640
    v_mul_hi_u32 v16, v13, s53
    v_lshlrev_b32 v18, 2, v13
    v_add_u32 v13, v16, v13
    ds_write_b32 v18, v35 offset:49984
    ds_write_b8_d16_hi v13, v42 offset:16640
    v_mul_hi_u32 v16, v14, s53
    v_lshlrev_b32 v17, 2, v14
    v_add_u32 v14, v16, v14
    ds_write_b32 v17, v36 offset:49984
    ds_write_b8 v14, v43 offset:16640
    v_mul_hi_u32 v16, v15, s53
    v_lshlrev_b32 v18, 2, v15
    v_add_u32 v15, v16, v15
    ds_write_b32 v18, v37 offset:49984
    ds_write_b8_d16_hi v15, v43 offset:16640
    s_waitcnt lgkmcnt(0)
    s_mov_b64 exec, s[64:65]
    buffer_store_dwordx4 v[80:83], v1, s[28:31], s66 offen sc0 sc1
    s_mov_b64 exec, -1
    s_mov_b64 exec, s[40:41]
    v_mul_hi_u32 v16, v8, s53
    v_lshlrev_b32 v17, 2, v8
    v_add_u32 v8, v16, v8
    ds_write_b32 v17, v44 offset:49984
    ds_write_b8 v8, v46 offset:16640
    s_mov_b64 exec, -1
    s_waitcnt lgkmcnt(0)
    s_barrier
    s_waitcnt vmcnt(10)
    s_mov_b32 s42, 0x7fff7fff
    v_and_b32 v8, s42, v84
    v_and_b32 v9, s42, v85
    v_and_b32 v10, s42, v86
    v_and_b32 v11, s42, v87
    v_pk_max_u16 v8, v8, v10
    v_pk_max_u16 v9, v9, v11
    v_pk_max_u16 v8, v8, v9
    s_add_u32 s42, s71, 1
    s_lshl_b32 s42, s42, 7
    v_max_u32_sdwa v8, v8, v8 dst_sel:DWORD dst_unused:UNUSED_PAD src0_sel:WORD_0 src1_sel:WORD_1
    s_lshl_b32 s44, s2, 4
    s_add_u32 s44, s44, s50
    v_cmp_le_u32 vcc, s42, v8
    s_add_u32 s44, s44, 0x4c01000
    s_sub_i32 s43, 131, s71
    s_cmp_lg_u64 vcc, 0
    s_cselect_b32 s42, 1, 0
    v_mov_b32 v9, s42
    s_mov_b64 exec, 1
    buffer_store_byte v9, v5, s[28:31], s44 offen
    s_mov_b64 exec, -1
    s_cmp_eq_u32 s70, 1
    s_cbranch_scc1 P_NOMP
    v_lshlrev_b32 v19, 16, v84
    v_and_b32 v20, s49, v84
    v_ldexp_f32 v19, v19, s43
    v_ldexp_f32 v20, v20, s43
    v_cvt_pk_f16_f32 v84, v19, v20
    v_lshlrev_b32 v19, 16, v85
    v_and_b32 v20, s49, v85
    v_ldexp_f32 v19, v19, s43
    v_ldexp_f32 v20, v20, s43
    v_cvt_pk_f16_f32 v85, v19, v20
    v_lshlrev_b32 v19, 16, v86
    v_and_b32 v20, s49, v86
    v_ldexp_f32 v19, v19, s43
    v_ldexp_f32 v20, v20, s43
    v_cvt_pk_f16_f32 v86, v19, v20
    v_lshlrev_b32 v19, 16, v87
    v_and_b32 v20, s49, v87
    v_ldexp_f32 v19, v19, s43
    v_ldexp_f32 v20, v20, s43
    v_cvt_pk_f16_f32 v87, v19, v20
    v_and_b32 v47, 0x3f0, v1
    buffer_store_dwordx4 v[84:87], v47, s[28:31], s45 offen sc0 sc1
P_NOMP:
    s_movk_i32 s42, 142
    v_cmp_gt_u32 s[56:57], s42, v0
    v_mul_u32_u24 v8, 12, v0
    v_add_u32 v8, 49984, v8
    s_mul_i32 s42, s2, 266752
    s_add_u32 s42, s42, 133376
    ds_read2_b32 v[48:49], v8 offset0:0 offset1:1
    ds_read_b32 v50, v8 offset:8
    ds_read_b32 v51, v6 offset:16640
    v_add_u32 v8, 12288, v8
    ds_read2_b32 v[52:53], v8 offset0:0 offset1:1
    ds_read_b32 v54, v8 offset:8
    ds_read_b32 v55, v6 offset:20736
    v_add_u32 v8, 12288, v8
    ds_read2_b32 v[56:57], v8 offset0:0 offset1:1
    ds_read_b32 v58, v8 offset:8
    ds_read_b32 v59, v6 offset:24832
    v_add_u32 v8, 12288, v8
    ds_read2_b32 v[60:61], v8 offset0:0 offset1:1
    ds_read_b32 v62, v8 offset:8
    ds_read_b32 v63, v6 offset:28928
    v_add_u32 v8, 12288, v8
    ds_read2_b32 v[64:65], v8 offset0:0 offset1:1
    ds_read_b32 v66, v8 offset:8
    ds_read_b32 v67, v6 offset:33024
    v_add_u32 v8, 12288, v8
    s_waitcnt lgkmcnt(12)
    buffer_store_dwordx4 v[48:51], v1, s[28:31], s42 offen sc0 sc1
    s_add_u32 s42, s42, 16384
    ds_read2_b32 v[68:69], v8 offset0:0 offset1:1
    ds_read_b32 v70, v8 offset:8
    ds_read_b32 v71, v6 offset:37120
    v_add_u32 v8, 12288, v8
    s_waitcnt lgkmcnt(12)
    buffer_store_dwordx4 v[52:55], v1, s[28:31], s42 offen sc0 sc1
    s_add_u32 s42, s42, 16384
    ds_read2_b32 v[72:73], v8 offset0:0 offset1:1
    ds_read_b32 v74, v8 offset:8
    ds_read_b32 v75, v6 offset:41216
    v_add_u32 v8, 12288, v8
    s_waitcnt lgkmcnt(12)
    buffer_store_dwordx4 v[56:59], v1, s[28:31], s42 offen sc0 sc1
    s_add_u32 s42, s42, 16384
    ds_read2_b32 v[76:77], v8 offset0:0 offset1:1
    ds_read_b32 v78, v8 offset:8
    ds_read_b32 v79, v6 offset:45312
    v_add_u32 v8, 12288, v8
    s_waitcnt lgkmcnt(12)
    buffer_store_dwordx4 v[60:63], v1, s[28:31], s42 offen sc0 sc1
    s_add_u32 s42, s42, 16384
    s_mov_b64 exec, s[56:57]
    ds_read2_b32 v[80:81], v8 offset0:0 offset1:1
    ds_read_b32 v82, v8 offset:8
    ds_read_b32 v83, v6 offset:49408
    s_mov_b64 exec, -1
    s_waitcnt lgkmcnt(9)
    buffer_store_dwordx4 v[64:67], v1, s[28:31], s42 offen sc0 sc1
    s_add_u32 s42, s42, 16384
    s_waitcnt lgkmcnt(6)
    buffer_store_dwordx4 v[68:71], v1, s[28:31], s42 offen sc0 sc1
    s_add_u32 s42, s42, 16384
    s_waitcnt lgkmcnt(3)
    buffer_store_dwordx4 v[72:75], v1, s[28:31], s42 offen sc0 sc1
    s_add_u32 s42, s42, 16384
    s_waitcnt lgkmcnt(0)
    buffer_store_dwordx4 v[76:79], v1, s[28:31], s42 offen sc0 sc1
    s_add_u32 s42, s42, 16384
    s_waitcnt lgkmcnt(0)
    s_mov_b64 exec, s[56:57]
    buffer_store_dwordx4 v[80:83], v1, s[28:31], s42 offen sc0 sc1
    s_mov_b64 exec, -1
P_END:
    s_endpgm
.globl acc_kernel
.p2align 8
.type acc_kernel,@function
acc_kernel:
    s_cmp_ge_u32 s2, 256
    s_cbranch_scc1 Q_END
    s_load_dwordx2 s[4:5], s[0:1], 0
    s_load_dwordx2 s[6:7], s[0:1], 104
    s_and_b32 s3, s2, 7
    s_lshl_b32 s3, s3, 5
    s_lshr_b32 s16, s2, 3
    s_add_u32 s3, s3, s16
    v_and_b32 v1, 3, v0
    v_lshlrev_b32 v2, 4, v0
    v_lshrrev_b32 v3, 2, v0
    v_and_b32 v4, 1, v0
    v_mul_u32_u24 v92, 16448, v3
    v_lshl_add_u32 v93, v1, 4, v92
    v_lshlrev_b32 v94, 2, v0
    v_mov_b32 v127, 0
    s_lshl_b32 s17, s3, 6
    s_add_u32 s17, s17, 0x4400000
    s_mov_b32 s19, 0x4c01000
    s_lshr_b32 s20, s3, 6
    s_mul_i32 s20, s20, 802816
    s_add_u32 s20, s20, 0x4c10000
    v_cmp_gt_u32 s[22:23], 64, v0
    v_readfirstlane_b32 s21, v0
    s_nop 3
    s_lshl_b32 s50, s21, 4
    s_mov_b32 m0, s50
    s_waitcnt lgkmcnt(0)
    s_mov_b32 s8, s4
    s_and_b32 s9, s5, 0xffff
    s_mov_b32 s10, 0x30d400
    s_mov_b32 s11, 0x00020000
    s_mov_b32 s12, s6
    s_and_b32 s13, s7, 0xffff
    s_mov_b32 s14, 0x10000000
    s_mov_b32 s15, 0x00020000
    s_lshl_b32 s16, s2, 2
    s_add_u32 s16, s16, 0x4c00400
    s_load_dword s27, s[6:7], s16
    buffer_load_dwordx4 v[58:61], v93, s[12:15], s17 offen offset:64
    buffer_load_dword v125, v94, s[12:15], s19 offen
    s_mov_b64 exec, -1
    s_cmp_ge_u32 s50, 8192
    s_cbranch_scc1 Q_C_18
    s_add_u32 s21, s20, 49152
    buffer_load_dwordx4 v[88:91], v2, s[12:15], s21 offen
Q_C_18:
    s_add_u32 s21, s20, 0
    buffer_load_dwordx4 v[76:79], v2, s[12:15], s21 offen
    s_add_u32 s21, s20, 16384
    buffer_load_dwordx4 v[80:83], v2, s[12:15], s21 offen
    s_add_u32 s21, s20, 32768
    buffer_load_dwordx4 v[84:87], v2, s[12:15], s21 offen
    s_add_u32 s20, s20, 57344
    s_mov_b32 s16, 266752
    v_mul_lo_u32 v5, v3, s16
    s_bitcmp1_b32 s3, 0
    s_cselect_b32 s51, -4, 4
    s_cselect_b32 s52, -1, 1
    s_cselect_b32 s53, 3, 0
    s_cselect_b32 s16, 133356, 0
    v_add_u32 v5, s16, v5
    v_add_u32 v6, 133376, v5
    v_cmp_eq_u32 s[36:37], 3, v1
    v_and_b32 v4, 63, v0
    v_cmp_lt_u32 s[38:39], 1, v1
    v_lshl_add_u32 v1, v1, 2, s53
    s_mov_b32 s44, 0
    s_lshr_b32 s45, s3, 6
    s_mul_i32 s45, s45, 800016
    v_add_u32 v3, 57344, v2
    v_mov_b32 v54, 0
    v_mov_b32 v55, 0
    v_mov_b32 v56, 0
    v_mov_b32 v57, 0
    ds_write_b128 v3, v[54:57] offset:0
    ds_write_b128 v3, v[54:57] offset:16384
    ds_write_b128 v3, v[54:57] offset:32768
    ds_write_b128 v3, v[54:57] offset:49152
    v_add_u32 v98, 65536, v3
    ds_write_b128 v98, v[54:57] offset:0
    ds_write_b128 v98, v[54:57] offset:16384
    s_movk_i32 s16, 106
    v_cmp_gt_u32 s[24:25], s16, v0
    s_mov_b64 exec, s[24:25]
    ds_write_b128 v98, v[54:57] offset:32768
    s_mov_b64 exec, -1
    v_mov_b32 v126, 157344
    s_mov_b64 exec, 1
    ds_write_b128 v126, v[54:57]
    s_mov_b64 exec, -1
    s_mov_b32 s30, 0xffff0000
    s_mov_b32 s31, 57344
    s_mov_b32 s35, 0xfc000000
    v_mov_b32 v102, 18
    v_mov_b32 v116, 3
    v_mov_b32 v103, 0xfffc
    s_waitcnt vmcnt(3)
    v_mov_b32_dpp v8, v58 quad_perm:[0,0,0,0] row_mask:0xf bank_mask:0xf
    v_mov_b32_dpp v9, v59 quad_perm:[0,0,0,0] row_mask:0xf bank_mask:0xf
    v_mov_b32_dpp v10, v60 quad_perm:[0,0,0,0] row_mask:0xf bank_mask:0xf
    v_mov_b32_dpp v11, v61 quad_perm:[0,0,0,0] row_mask:0xf bank_mask:0xf
    v_mov_b32_dpp v12, v58 quad_perm:[1,1,1,1] row_mask:0xf bank_mask:0xf
    v_mov_b32_dpp v13, v59 quad_perm:[1,1,1,1] row_mask:0xf bank_mask:0xf
    v_mov_b32_dpp v14, v60 quad_perm:[1,1,1,1] row_mask:0xf bank_mask:0xf
    v_mov_b32_dpp v15, v61 quad_perm:[1,1,1,1] row_mask:0xf bank_mask:0xf
    v_mov_b32_dpp v17, v58 quad_perm:[2,2,2,2] row_mask:0xf bank_mask:0xf
    v_mov_b32_dpp v18, v59 quad_perm:[2,2,2,2] row_mask:0xf bank_mask:0xf
    v_mov_b32_dpp v19, v60 quad_perm:[2,2,2,2] row_mask:0xf bank_mask:0xf
    v_mov_b32_dpp v20, v61 quad_perm:[2,2,2,2] row_mask:0xf bank_mask:0xf
    v_mov_b32_dpp v21, v58 quad_perm:[3,3,3,3] row_mask:0xf bank_mask:0xf
    v_mov_b32_dpp v22, v59 quad_perm:[3,3,3,3] row_mask:0xf bank_mask:0xf
    v_mov_b32_dpp v23, v60 quad_perm:[3,3,3,3] row_mask:0xf bank_mask:0xf
    v_mov_b32_dpp v24, v61 quad_perm:[3,3,3,3] row_mask:0xf bank_mask:0xf
    v_lshrrev_b32 v16, 16, v15
    v_lshl_or_b32 v16, v16, 16, v16
    v_lshrrev_b32 v25, 16, v24
    v_lshl_or_b32 v25, v25, 16, v25
    v_mov_b32 v93, 0
    s_mov_b64 exec, -1
    v_and_b32_sdwa v92, v8, v103 dst_sel:DWORD dst_unused:UNUSED_PAD src0_sel:WORD_1 src1_sel:DWORD
    v_sub_u32_sdwa v100, v9, v8 dst_sel:DWORD dst_unused:UNUSED_PAD src0_sel:WORD_0 src1_sel:WORD_1
    v_add_u32 v92, v92, v1
    v_sub_u32_sdwa v99, v92, v8 dst_sel:DWORD dst_unused:UNUSED_PAD src0_sel:DWORD src1_sel:WORD_1
    v_mad_i32_i24 v98, v92, s51, v5
    v_cmp_lt_u32 s[54:55], v99, v100
    v_add_u32 v99, s52, v99
    v_cmp_lt_u32 s[56:57], v99, v100
    v_add_u32 v99, s52, v99
    v_cmp_lt_u32 s[58:59], v99, v100
    s_or_b64 vcc, s[54:55], s[56:57]
    s_or_b64 vcc, vcc, s[58:59]
    s_or_b64 exec, vcc, 1
    buffer_load_dwordx4 v[26:29], v98, s[12:15], 0 offen
    s_mov_b64 exec, -1
    v_and_b32_sdwa v92, v17, v103 dst_sel:DWORD dst_unused:UNUSED_PAD src0_sel:WORD_1 src1_sel:DWORD
    v_sub_u32_sdwa v100, v18, v17 dst_sel:DWORD dst_unused:UNUSED_PAD src0_sel:WORD_0 src1_sel:WORD_1
    v_add_u32 v92, v92, v1
    v_sub_u32_sdwa v99, v92, v17 dst_sel:DWORD dst_unused:UNUSED_PAD src0_sel:DWORD src1_sel:WORD_1
    v_mad_i32_i24 v98, v92, s51, v6
    v_cmp_lt_u32 s[60:61], v99, v100
    v_add_u32 v99, s52, v99
    v_cmp_lt_u32 s[62:63], v99, v100
    v_add_u32 v99, s52, v99
    v_cmp_lt_u32 s[64:65], v99, v100
    s_or_b64 vcc, s[60:61], s[62:63]
    s_or_b64 vcc, vcc, s[64:65]
    s_or_b64 exec, vcc, 1
    buffer_load_dwordx4 v[30:33], v98, s[12:15], 0 offen
    s_mov_b64 exec, -1
    v_and_b32_sdwa v92, v9, v103 dst_sel:DWORD dst_unused:UNUSED_PAD src0_sel:WORD_0 src1_sel:DWORD
    v_sub_u32_sdwa v100, v9, v9 dst_sel:DWORD dst_unused:UNUSED_PAD src0_sel:WORD_1 src1_sel:WORD_0
    v_add_u32 v92, v92, v1
    v_sub_u32_sdwa v99, v92, v9 dst_sel:DWORD dst_unused:UNUSED_PAD src0_sel:DWORD src1_sel:WORD_0
    v_mad_i32_i24 v98, v92, s51, v5
    v_cmp_lt_u32 s[66:67], v99, v100
    v_add_u32 v99, s52, v99
    v_cmp_lt_u32 s[68:69], v99, v100
    v_add_u32 v99, s52, v99
    v_cmp_lt_u32 s[70:71], v99, v100
    s_or_b64 vcc, s[66:67], s[68:69]
    s_or_b64 vcc, vcc, s[70:71]
    s_or_b64 exec, vcc, 1
    buffer_load_dwordx4 v[34:37], v98, s[12:15], 0 offen
    s_mov_b64 exec, -1
    s_bitcmp1_b32 s3, 0
    s_cselect_b32 s16, 33340, 0
    v_mov_b32 v100, s16
    v_lshrrev_b32 v94, 16, v8
    v_lshrrev_b32 v95, 16, v16
    v_mad_i32_i24 v94, v94, s52, v100
    v_mad_i32_i24 v95, v95, s52, v100
    v_sub_u32 v96, v94, v95
    v_lshrrev_b32 v94, 2, v94
    v_lshrrev_b32 v95, 2, v95
    v_sub_u32 v94, v95, v94
    v_add_u32 v96, v96, v94
    v_lshrrev_b32 v94, 16, v17
    v_lshrrev_b32 v95, 16, v25
    v_mad_i32_i24 v94, v94, s52, v100
    v_mad_i32_i24 v95, v95, s52, v100
    v_sub_u32 v97, v94, v95
    v_lshrrev_b32 v94, 2, v94
    v_lshrrev_b32 v95, 2, v95
    v_sub_u32 v94, v95, v94
    v_add_u32 v97, v97, v94
    v_add_u32 v94, v96, v97
    s_nop 1
    v_add_u32_dpp v94, v94, v94 row_shr:1 row_mask:0xf bank_mask:0xf bound_ctrl:0
    s_nop 1
    v_add_u32_dpp v94, v94, v94 row_shr:2 row_mask:0xf bank_mask:0xf bound_ctrl:0
    s_nop 1
    v_add_u32_dpp v94, v94, v94 row_shr:4 row_mask:0xf bank_mask:0xf bound_ctrl:0
    s_nop 1
    v_add_u32_dpp v94, v94, v94 row_shr:8 row_mask:0xf bank_mask:0xf bound_ctrl:0
    s_nop 1
    v_add_u32_dpp v94, v94, v94 row_bcast:15 row_mask:0xa bank_mask:0xf
    s_nop 1
    v_add_u32_dpp v94, v94, v94 row_bcast:31 row_mask:0xc bank_mask:0xf
    s_nop 1
    v_readlane_b32 s32, v94, 63
    s_nop 3
    s_mul_i32 s32, s32, s52
    s_mov_b32 s26, 0x44080000
    s_mov_b32 s28, 0x42c00000
    s_mov_b64 exec, -1
    v_mov_b32_dpp v106, v61 quad_perm:[0,0,2,2] row_mask:0xf bank_mask:0xf
    v_and_b32 v108, 1, v0
    v_cmp_eq_u32 vcc, 0, v108
    v_lshlrev_b32 v109, 16, v58
    v_lshl_add_u32 v108, v108, 5, -8
    v_cndmask_b32 v106, v106, v109, vcc
    v_cndmask_b32 v107, v5, v6, s[38:39]
    s_add_u32 s42, s53, 16
    s_mul_i32 s42, s42, s51
    v_add_u32 v107, s42, v107
    s_lshl_b32 s42, s51, 2
    s_and_b32 s43, s3, 1
    s_add_u32 s43, s43, 16
    s_mov_b32 s46, s50
    v_and_b32_sdwa v92, v106, v103 dst_sel:DWORD dst_unused:UNUSED_PAD src0_sel:WORD_1 src1_sel:DWORD
    v_sub_u32_sdwa v93, v58, v92 dst_sel:DWORD dst_unused:UNUSED_PAD src0_sel:WORD_0 src1_sel:DWORD
    v_cmpx_lt_i32 vcc, 16, v93
    s_cbranch_execz Q_D_19
    v_mad_i32_i24 v110, v92, s51, v107
    v_subrev_u32 v93, s43, v93
Q_D_20:
    v_mbcnt_lo_u32_b32 v109, exec_lo, 0
    v_mbcnt_hi_u32_b32 v109, exec_hi, v109
    v_min_u32 v111, 3, v93
    v_add_u32 v109, s44, v109
    v_add_u32 v111, v111, v108
    s_bcnt1_i32_b64 s47, exec
    v_min_u32 v109, 63, v109
    s_add_u32 s44, s44, s47
    v_lshl_add_u32 v109, v109, 3, s46
    ds_write_b64 v109, v[110:111]
    v_cmpx_lt_i32 vcc, 4, v93
    s_cbranch_execz Q_D_19
    s_cmp_ge_u32 s44, 64
    s_cbranch_scc1 Q_D_19
    v_add_u32 v110, s42, v110
    v_subrev_u32 v93, 4, v93
    s_branch Q_D_20
Q_D_19:
    s_mov_b64 exec, -1
    v_and_b32_sdwa v92, v58, v103 dst_sel:DWORD dst_unused:UNUSED_PAD src0_sel:WORD_0 src1_sel:DWORD
    v_sub_u32_sdwa v93, v58, v92 dst_sel:DWORD dst_unused:UNUSED_PAD src0_sel:WORD_1 src1_sel:DWORD
    v_cmpx_lt_i32 vcc, 16, v93
    s_cbranch_execz Q_D_21
    v_mad_i32_i24 v110, v92, s51, v107
    v_subrev_u32 v93, s43, v93
Q_D_22:
    v_mbcnt_lo_u32_b32 v109, exec_lo, 0
    v_mbcnt_hi_u32_b32 v109, exec_hi, v109
    v_min_u32 v111, 3, v93
    v_add_u32 v109, s44, v109
    v_add_u32 v111, v111, v108
    v_add_u32 v111, 4, v111
    s_bcnt1_i32_b64 s47, exec
    v_min_u32 v109, 63, v109
    s_add_u32 s44, s44, s47
    v_lshl_add_u32 v109, v109, 3, s46
    ds_write_b64 v109, v[110:111]
    v_cmpx_lt_i32 vcc, 4, v93
    s_cbranch_execz Q_D_21
    s_cmp_ge_u32 s44, 64
    s_cbranch_scc1 Q_D_21
    v_add_u32 v110, s42, v110
    v_subrev_u32 v93, 4, v93
    s_branch Q_D_22
Q_D_21:
    s_mov_b64 exec, -1
    v_and_b32_sdwa v92, v58, v103 dst_sel:DWORD dst_unused:UNUSED_PAD src0_sel:WORD_1 src1_sel:DWORD
    v_sub_u32_sdwa v93, v59, v92 dst_sel:DWORD dst_unused:UNUSED_PAD src0_sel:WORD_0 src1_sel:DWORD
    v_cmpx_lt_i32 vcc, 16, v93
    s_cbranch_execz Q_D_23
    v_mad_i32_i24 v110, v92, s51, v107
    v_subrev_u32 v93, s43, v93
Q_D_24:
    v_mbcnt_lo_u32_b32 v109, exec_lo, 0
    v_mbcnt_hi_u32_b32 v109, exec_hi, v109
    v_min_u32 v111, 3, v93
    v_add_u32 v109, s44, v109
    v_add_u32 v111, v111, v108
    v_add_u32 v111, 8, v111
    s_bcnt1_i32_b64 s47, exec
    v_min_u32 v109, 63, v109
    s_add_u32 s44, s44, s47
    v_lshl_add_u32 v109, v109, 3, s46
    ds_write_b64 v109, v[110:111]
    v_cmpx_lt_i32 vcc, 4, v93
    s_cbranch_execz Q_D_23
    s_cmp_ge_u32 s44, 64
    s_cbranch_scc1 Q_D_23
    v_add_u32 v110, s42, v110
    v_subrev_u32 v93, 4, v93
    s_branch Q_D_24
Q_D_23:
    s_mov_b64 exec, -1
    v_and_b32_sdwa v92, v59, v103 dst_sel:DWORD dst_unused:UNUSED_PAD src0_sel:WORD_0 src1_sel:DWORD
    v_sub_u32_sdwa v93, v59, v92 dst_sel:DWORD dst_unused:UNUSED_PAD src0_sel:WORD_1 src1_sel:DWORD
    v_cmpx_lt_i32 vcc, 16, v93
    s_cbranch_execz Q_D_25
    v_mad_i32_i24 v110, v92, s51, v107
    v_subrev_u32 v93, s43, v93
Q_D_26:
    v_mbcnt_lo_u32_b32 v109, exec_lo, 0
    v_mbcnt_hi_u32_b32 v109, exec_hi, v109
    v_min_u32 v111, 3, v93
    v_add_u32 v109, s44, v109
    v_add_u32 v111, v111, v108
    v_add_u32 v111, 12, v111
    s_bcnt1_i32_b64 s47, exec
    v_min_u32 v109, 63, v109
    s_add_u32 s44, s44, s47
    v_lshl_add_u32 v109, v109, 3, s46
    ds_write_b64 v109, v[110:111]
    v_cmpx_lt_i32 vcc, 4, v93
    s_cbranch_execz Q_D_25
    s_cmp_ge_u32 s44, 64
    s_cbranch_scc1 Q_D_25
    v_add_u32 v110, s42, v110
    v_subrev_u32 v93, 4, v93
    s_branch Q_D_26
Q_D_25:
    s_mov_b64 exec, -1
    v_and_b32_sdwa v92, v59, v103 dst_sel:DWORD dst_unused:UNUSED_PAD src0_sel:WORD_1 src1_sel:DWORD
    v_sub_u32_sdwa v93, v60, v92 dst_sel:DWORD dst_unused:UNUSED_PAD src0_sel:WORD_0 src1_sel:DWORD
    v_cmpx_lt_i32 vcc, 16, v93
    s_cbranch_execz Q_D_27
    v_mad_i32_i24 v110, v92, s51, v107
    v_subrev_u32 v93, s43, v93
Q_D_28:
    v_mbcnt_lo_u32_b32 v109, exec_lo, 0
    v_mbcnt_hi_u32_b32 v109, exec_hi, v109
    v_min_u32 v111, 3, v93
    v_add_u32 v109, s44, v109
    v_add_u32 v111, v111, v108
    v_add_u32 v111, 16, v111
    s_bcnt1_i32_b64 s47, exec
    v_min_u32 v109, 63, v109
    s_add_u32 s44, s44, s47
    v_lshl_add_u32 v109, v109, 3, s46
    ds_write_b64 v109, v[110:111]
    v_cmpx_lt_i32 vcc, 4, v93
    s_cbranch_execz Q_D_27
    s_cmp_ge_u32 s44, 64
    s_cbranch_scc1 Q_D_27
    v_add_u32 v110, s42, v110
    v_subrev_u32 v93, 4, v93
    s_branch Q_D_28
Q_D_27:
    s_mov_b64 exec, -1
    v_and_b32_sdwa v92, v60, v103 dst_sel:DWORD dst_unused:UNUSED_PAD src0_sel:WORD_0 src1_sel:DWORD
    v_sub_u32_sdwa v93, v60, v92 dst_sel:DWORD dst_unused:UNUSED_PAD src0_sel:WORD_1 src1_sel:DWORD
    v_cmpx_lt_i32 vcc, 16, v93
    s_cbranch_execz Q_D_29
    v_mad_i32_i24 v110, v92, s51, v107
    v_subrev_u32 v93, s43, v93
Q_D_30:
    v_mbcnt_lo_u32_b32 v109, exec_lo, 0
    v_mbcnt_hi_u32_b32 v109, exec_hi, v109
    v_min_u32 v111, 3, v93
    v_add_u32 v109, s44, v109
    v_add_u32 v111, v111, v108
    v_add_u32 v111, 20, v111
    s_bcnt1_i32_b64 s47, exec
    v_min_u32 v109, 63, v109
    s_add_u32 s44, s44, s47
    v_lshl_add_u32 v109, v109, 3, s46
    ds_write_b64 v109, v[110:111]
    v_cmpx_lt_i32 vcc, 4, v93
    s_cbranch_execz Q_D_29
    s_cmp_ge_u32 s44, 64
    s_cbranch_scc1 Q_D_29
    v_add_u32 v110, s42, v110
    v_subrev_u32 v93, 4, v93
    s_branch Q_D_30
Q_D_29:
    s_mov_b64 exec, -1
    v_and_b32_sdwa v92, v60, v103 dst_sel:DWORD dst_unused:UNUSED_PAD src0_sel:WORD_1 src1_sel:DWORD
    v_sub_u32_sdwa v93, v61, v92 dst_sel:DWORD dst_unused:UNUSED_PAD src0_sel:WORD_0 src1_sel:DWORD
    v_cmpx_lt_i32 vcc, 16, v93
    s_cbranch_execz Q_D_31
    v_mad_i32_i24 v110, v92, s51, v107
    v_subrev_u32 v93, s43, v93
Q_D_32:
    v_mbcnt_lo_u32_b32 v109, exec_lo, 0
    v_mbcnt_hi_u32_b32 v109, exec_hi, v109
    v_min_u32 v111, 3, v93
    v_add_u32 v109, s44, v109
    v_add_u32 v111, v111, v108
    v_add_u32 v111, 24, v111
    s_bcnt1_i32_b64 s47, exec
    v_min_u32 v109, 63, v109
    s_add_u32 s44, s44, s47
    v_lshl_add_u32 v109, v109, 3, s46
    ds_write_b64 v109, v[110:111]
    v_cmpx_lt_i32 vcc, 4, v93
    s_cbranch_execz Q_D_31
    s_cmp_ge_u32 s44, 64
    s_cbranch_scc1 Q_D_31
    v_add_u32 v110, s42, v110
    v_subrev_u32 v93, 4, v93
    s_branch Q_D_32
Q_D_31:
    s_mov_b64 exec, -1
    v_and_b32_sdwa v92, v61, v103 dst_sel:DWORD dst_unused:UNUSED_PAD src0_sel:WORD_0 src1_sel:DWORD
    v_sub_u32_sdwa v93, v61, v92 dst_sel:DWORD dst_unused:UNUSED_PAD src0_sel:WORD_1 src1_sel:DWORD
    v_cmpx_lt_i32 vcc, 16, v93
    s_cbranch_execz Q_D_33
    v_mad_i32_i24 v110, v92, s51, v107
    v_subrev_u32 v93, s43, v93
Q_D_34:
    v_mbcnt_lo_u32_b32 v109, exec_lo, 0
    v_mbcnt_hi_u32_b32 v109, exec_hi, v109
    v_min_u32 v111, 3, v93
    v_add_u32 v109, s44, v109
    v_add_u32 v111, v111, v108
    v_add_u32 v111, 28, v111
    s_bcnt1_i32_b64 s47, exec
    v_min_u32 v109, 63, v109
    s_add_u32 s44, s44, s47
    v_lshl_add_u32 v109, v109, 3, s46
    ds_write_b64 v109, v[110:111]
    v_cmpx_lt_i32 vcc, 4, v93
    s_cbranch_execz Q_D_33
    s_cmp_ge_u32 s44, 64
    s_cbranch_scc1 Q_D_33
    v_add_u32 v110, s42, v110
    v_subrev_u32 v93, 4, v93
    s_branch Q_D_34
Q_D_33:
    s_mov_b64 exec, -1
    v_lshl_add_u32 v109, v4, 3, s46
    ds_read_b64 v[104:105], v109
    v_cmp_gt_u32 s[38:39], s44, v4
    s_waitcnt lgkmcnt(0)
    v_and_b32 v109, 3, v105
    v_lshrrev_b32 v105, 2, v105
    v_cndmask_b32 v109, 0, v109, s[38:39]
    v_cndmask_b32 v105, -1, v105, s[38:39]
    v_cmp_lt_u32 s[38:39], 0, v109
    v_cmp_lt_u32 s[42:43], 1, v109
    v_cmp_lt_u32 vcc, 2, v109
    s_bitcmp1_b32 s3, 0
    s_cselect_b64 s[40:41], vcc, s[38:39]
    s_cselect_b64 s[44:45], s[38:39], vcc
    s_mov_b32 s46, 0
    s_mov_b64 s[48:49], 1
    s_mov_b64 exec, -1
    s_add_u32 s47, s46, 0
    v_cmp_eq_u32 vcc, s47, v105
    s_or_b64 exec, vcc, s[48:49]
    buffer_load_dwordx4 v[106:109], v104, s[12:15], 0 offen
    s_waitcnt vmcnt(4)
    s_mov_b64 exec, -1
    ds_write_addtid_b32 v76 offset:0
    ds_write_addtid_b32 v77 offset:256
    ds_write_addtid_b32 v78 offset:512
    ds_write_addtid_b32 v79 offset:768
    ds_write_addtid_b32 v80 offset:16384
    ds_write_addtid_b32 v81 offset:16640
    ds_write_addtid_b32 v82 offset:16896
    ds_write_addtid_b32 v83 offset:17152
    ds_write_addtid_b32 v84 offset:32768
    ds_write_addtid_b32 v85 offset:33024
    ds_write_addtid_b32 v86 offset:33280
    ds_write_addtid_b32 v87 offset:33536
    s_cmp_ge_u32 s50, 8192
    s_cbranch_scc1 Q_F_35
    ds_write_addtid_b32 v88 offset:49152
    ds_write_addtid_b32 v89 offset:49408
    ds_write_addtid_b32 v90 offset:49664
    ds_write_addtid_b32 v91 offset:49920
Q_F_35:
    s_mov_b64 exec, -1
    s_cmp_ge_u32 s50, 8192
    s_cbranch_scc1 Q_C_36
    s_add_u32 s21, s20, 49152
    buffer_load_dwordx4 v[88:91], v2, s[12:15], s21 offen
Q_C_36:
    s_add_u32 s21, s20, 0
    buffer_load_dwordx4 v[76:79], v2, s[12:15], s21 offen
    s_add_u32 s21, s20, 16384
    buffer_load_dwordx4 v[80:83], v2, s[12:15], s21 offen
    s_add_u32 s21, s20, 32768
    buffer_load_dwordx4 v[84:87], v2, s[12:15], s21 offen
    s_add_u32 s20, s20, 57344
    s_mov_b32 s33, 0
    s_waitcnt vmcnt(3) lgkmcnt(0)
    s_barrier
    s_mov_b64 exec, -1
    v_lshlrev_b32_sdwa v58, v116, v26 dst_sel:WORD_0 dst_unused:UNUSED_PAD src0_sel:DWORD src1_sel:DWORD
    v_lshlrev_b32_sdwa v60, v116, v27 dst_sel:WORD_0 dst_unused:UNUSED_PAD src0_sel:DWORD src1_sel:DWORD
    v_lshlrev_b32_sdwa v62, v116, v28 dst_sel:WORD_0 dst_unused:UNUSED_PAD src0_sel:DWORD src1_sel:DWORD
    s_mov_b64 exec, s[54:55]
    ds_read_b64 v[58:59], v58
    s_mov_b64 exec, s[56:57]
    ds_read_b64 v[60:61], v60
    s_mov_b64 exec, s[58:59]
    ds_read_b64 v[62:63], v62
    s_mov_b64 exec, -1
    v_lshlrev_b32_sdwa v64, v116, v30 dst_sel:WORD_0 dst_unused:UNUSED_PAD src0_sel:DWORD src1_sel:DWORD
    v_lshlrev_b32_sdwa v66, v116, v31 dst_sel:WORD_0 dst_unused:UNUSED_PAD src0_sel:DWORD src1_sel:DWORD
    v_lshlrev_b32_sdwa v68, v116, v32 dst_sel:WORD_0 dst_unused:UNUSED_PAD src0_sel:DWORD src1_sel:DWORD
    s_mov_b64 exec, s[60:61]
    ds_read_b64 v[64:65], v64
    s_mov_b64 exec, s[62:63]
    ds_read_b64 v[66:67], v66
    s_mov_b64 exec, s[64:65]
    ds_read_b64 v[68:69], v68
    s_mov_b64 exec, -1
    s_add_u32 s47, s46, 0
    v_cmpx_eq_u32 vcc, s47, v105
    v_lshlrev_b32_sdwa v110, v116, v106 dst_sel:WORD_0 dst_unused:UNUSED_PAD src0_sel:DWORD src1_sel:DWORD
    v_lshlrev_b32_sdwa v112, v116, v107 dst_sel:WORD_0 dst_unused:UNUSED_PAD src0_sel:DWORD src1_sel:DWORD
    v_lshlrev_b32_sdwa v114, v116, v108 dst_sel:WORD_0 dst_unused:UNUSED_PAD src0_sel:DWORD src1_sel:DWORD
    s_and_b64 exec, vcc, s[40:41]
    ds_read_b64 v[110:111], v110
    s_and_b64 exec, vcc, s[42:43]
    ds_read_b64 v[112:113], v112
    s_and_b64 exec, vcc, s[44:45]
    ds_read_b64 v[114:115], v114
    s_mov_b64 exec, -1
    v_and_b32_sdwa v92, v18, v103 dst_sel:DWORD dst_unused:UNUSED_PAD src0_sel:WORD_0 src1_sel:DWORD
    v_sub_u32_sdwa v100, v18, v18 dst_sel:DWORD dst_unused:UNUSED_PAD src0_sel:WORD_1 src1_sel:WORD_0
    v_add_u32 v92, v92, v1
    v_sub_u32_sdwa v99, v92, v18 dst_sel:DWORD dst_unused:UNUSED_PAD src0_sel:DWORD src1_sel:WORD_0
    v_mad_i32_i24 v98, v92, s51, v6
    v_cmp_lt_u32 s[72:73], v99, v100
    v_add_u32 v99, s52, v99
    v_cmp_lt_u32 s[74:75], v99, v100
    v_add_u32 v99, s52, v99
    v_cmp_lt_u32 s[76:77], v99, v100
    s_or_b64 vcc, s[72:73], s[74:75]
    s_or_b64 vcc, vcc, s[76:77]
    s_or_b64 exec, vcc, 1
    buffer_load_dwordx4 v[38:41], v98, s[12:15], 0 offen
    s_mov_b64 exec, -1
    v_and_b32_sdwa v92, v18, v103 dst_sel:DWORD dst_unused:UNUSED_PAD src0_sel:WORD_1 src1_sel:DWORD
    v_sub_u32_sdwa v100, v19, v18 dst_sel:DWORD dst_unused:UNUSED_PAD src0_sel:WORD_0 src1_sel:WORD_1
    v_add_u32 v92, v92, v1
    v_sub_u32_sdwa v99, v92, v18 dst_sel:DWORD dst_unused:UNUSED_PAD src0_sel:DWORD src1_sel:WORD_1
    v_mad_i32_i24 v98, v92, s51, v6
    v_cmp_lt_u32 s[84:85], v99, v100
    v_add_u32 v99, s52, v99
    v_cmp_lt_u32 s[86:87], v99, v100
    v_add_u32 v99, s52, v99
    v_cmp_lt_u32 s[88:89], v99, v100
    s_or_b64 vcc, s[84:85], s[86:87]
    s_or_b64 vcc, vcc, s[88:89]
    s_or_b64 exec, vcc, 1
    buffer_load_dwordx4 v[46:49], v98, s[12:15], 0 offen
    s_mov_b64 exec, -1
    s_add_u32 s47, s46, 1
    v_cmp_eq_u32 vcc, s47, v105
    s_or_b64 exec, vcc, s[48:49]
    buffer_load_dwordx4 v[106:109], v104, s[12:15], 0 offen
    s_waitcnt vmcnt(3) lgkmcnt(0)
Q_LOOP:
    s_barrier
    s_mov_b64 exec, -1
    ds_write_addtid_b32 v76 offset:0
    ds_write_addtid_b32 v77 offset:256
    ds_write_addtid_b32 v78 offset:512
    ds_write_addtid_b32 v79 offset:768
    ds_write_addtid_b32 v80 offset:16384
    ds_write_addtid_b32 v81 offset:16640
    ds_write_addtid_b32 v82 offset:16896
    ds_write_addtid_b32 v83 offset:17152
    ds_write_addtid_b32 v84 offset:32768
    ds_write_addtid_b32 v85 offset:33024
    ds_write_addtid_b32 v86 offset:33280
    ds_write_addtid_b32 v87 offset:33536
    s_cmp_ge_u32 s50, 8192
    s_cbranch_scc1 Q_F_37
    ds_write_addtid_b32 v88 offset:49152
    ds_write_addtid_b32 v89 offset:49408
    ds_write_addtid_b32 v90 offset:49664
    ds_write_addtid_b32 v91 offset:49920
Q_F_37:
    s_cmp_eq_u32 s33, 3
    s_cselect_b64 exec, 1, -1
    s_cmp_ge_u32 s50, 8192
    s_cbranch_scc1 Q_C_38
    s_add_u32 s21, s20, 49152
    buffer_load_dwordx4 v[88:91], v2, s[12:15], s21 offen
Q_C_38:
    s_add_u32 s21, s20, 0
    buffer_load_dwordx4 v[76:79], v2, s[12:15], s21 offen
    s_add_u32 s21, s20, 16384
    buffer_load_dwordx4 v[80:83], v2, s[12:15], s21 offen
    s_add_u32 s21, s20, 32768
    buffer_load_dwordx4 v[84:87], v2, s[12:15], s21 offen
    s_add_u32 s20, s20, 57344
    s_mov_b64 exec, s[54:55]
    v_lshlrev_b32_sdwa v92, v102, v29 dst_sel:DWORD dst_unused:UNUSED_PAD src0_sel:DWORD src1_sel:BYTE_0
    v_bfe_u32 v93, v26, 13, 13
    v_and_or_b32 v92, v26, s35, v92
    v_lshl_add_u32 v93, v93, 3, s31
    v_fma_mix_f32 v96, v59, v92, s28 op_sel:[0,1,0] op_sel_hi:[1,1,0]
    v_fma_mix_f32 v97, v59, v92, s28 op_sel:[1,1,0] op_sel_hi:[1,1,0]
    s_waitcnt lgkmcnt(0)
    ds_add_u64 v93, v[96:97] offset:50000
    v_fma_mix_f32 v94, v58, v92, s26 op_sel:[0,1,0] op_sel_hi:[1,1,0]
    v_fma_mix_f32 v95, v58, v92, s28 op_sel:[1,1,0] op_sel_hi:[1,1,0]
    ds_add_u64 v93, v[94:95]
    s_mov_b64 exec, s[56:57]
    v_lshlrev_b32_sdwa v92, v102, v29 dst_sel:DWORD dst_unused:UNUSED_PAD src0_sel:DWORD src1_sel:BYTE_1
    v_bfe_u32 v93, v27, 13, 13
    v_and_or_b32 v92, v27, s35, v92
    v_lshl_add_u32 v93, v93, 3, s31
    v_fma_mix_f32 v96, v61, v92, s28 op_sel:[0,1,0] op_sel_hi:[1,1,0]
    v_fma_mix_f32 v97, v61, v92, s28 op_sel:[1,1,0] op_sel_hi:[1,1,0]
    ds_add_u64 v93, v[96:97] offset:50000
    v_fma_mix_f32 v94, v60, v92, s26 op_sel:[0,1,0] op_sel_hi:[1,1,0]
    v_fma_mix_f32 v95, v60, v92, s28 op_sel:[1,1,0] op_sel_hi:[1,1,0]
    ds_add_u64 v93, v[94:95]
    s_mov_b64 exec, s[58:59]
    v_lshlrev_b32_sdwa v92, v102, v29 dst_sel:DWORD dst_unused:UNUSED_PAD src0_sel:DWORD src1_sel:BYTE_2
    v_bfe_u32 v93, v28, 13, 13
    v_and_or_b32 v92, v28, s35, v92
    v_lshl_add_u32 v93, v93, 3, s31
    v_fma_mix_f32 v96, v63, v92, s28 op_sel:[0,1,0] op_sel_hi:[1,1,0]
    v_fma_mix_f32 v97, v63, v92, s28 op_sel:[1,1,0] op_sel_hi:[1,1,0]
    ds_add_u64 v93, v[96:97] offset:50000
    v_fma_mix_f32 v94, v62, v92, s26 op_sel:[0,1,0] op_sel_hi:[1,1,0]
    v_fma_mix_f32 v95, v62, v92, s28 op_sel:[1,1,0] op_sel_hi:[1,1,0]
    ds_add_u64 v93, v[94:95]
    s_waitcnt vmcnt(3)
    s_barrier
    s_mov_b64 exec, -1
    v_lshlrev_b32_sdwa v58, v116, v34 dst_sel:WORD_0 dst_unused:UNUSED_PAD src0_sel:DWORD src1_sel:DWORD
    v_lshlrev_b32_sdwa v60, v116, v35 dst_sel:WORD_0 dst_unused:UNUSED_PAD src0_sel:DWORD src1_sel:DWORD
    v_lshlrev_b32_sdwa v62, v116, v36 dst_sel:WORD_0 dst_unused:UNUSED_PAD src0_sel:DWORD src1_sel:DWORD
    s_mov_b64 exec, s[66:67]
    ds_read_b64 v[58:59], v58
    s_mov_b64 exec, s[68:69]
    ds_read_b64 v[60:61], v60
    s_mov_b64 exec, s[70:71]
    ds_read_b64 v[62:63], v62
    s_mov_b64 exec, -1
    s_add_u32 s47, s46, 1
    v_cmpx_eq_u32 vcc, s47, v105
    v_lshlrev_b32_sdwa v110, v116, v106 dst_sel:WORD_0 dst_unused:UNUSED_PAD src0_sel:DWORD src1_sel:DWORD
    v_lshlrev_b32_sdwa v112, v116, v107 dst_sel:WORD_0 dst_unused:UNUSED_PAD src0_sel:DWORD src1_sel:DWORD
    v_lshlrev_b32_sdwa v114, v116, v108 dst_sel:WORD_0 dst_unused:UNUSED_PAD src0_sel:DWORD src1_sel:DWORD
    s_and_b64 exec, vcc, s[40:41]
    ds_read_b64 v[110:111], v110
    s_and_b64 exec, vcc, s[42:43]
    ds_read_b64 v[112:113], v112
    s_and_b64 exec, vcc, s[44:45]
    ds_read_b64 v[114:115], v114
    s_mov_b64 exec, -1
    v_and_b32_sdwa v92, v9, v103 dst_sel:DWORD dst_unused:UNUSED_PAD src0_sel:WORD_1 src1_sel:DWORD
    v_sub_u32_sdwa v100, v10, v9 dst_sel:DWORD dst_unused:UNUSED_PAD src0_sel:WORD_0 src1_sel:WORD_1
    v_add_u32 v92, v92, v1
    v_sub_u32_sdwa v99, v92, v9 dst_sel:DWORD dst_unused:UNUSED_PAD src0_sel:DWORD src1_sel:WORD_1
    v_mad_i32_i24 v98, v92, s51, v5
    v_cmp_lt_u32 s[78:79], v99, v100
    v_add_u32 v99, s52, v99
    v_cmp_lt_u32 s[80:81], v99, v100
    v_add_u32 v99, s52, v99
    v_cmp_lt_u32 s[82:83], v99, v100
    s_or_b64 vcc, s[78:79], s[80:81]
    s_or_b64 vcc, vcc, s[82:83]
    s_or_b64 exec, vcc, 1
    buffer_load_dwordx4 v[42:45], v98, s[12:15], 0 offen
    s_mov_b64 exec, s[60:61]
    v_lshlrev_b32_sdwa v92, v102, v33 dst_sel:DWORD dst_unused:UNUSED_PAD src0_sel:DWORD src1_sel:BYTE_0
    v_bfe_u32 v93, v30, 13, 13
    v_and_or_b32 v92, v30, s35, v92
    v_lshl_add_u32 v93, v93, 3, s31
    v_fma_mix_f32 v96, v65, v92, s28 op_sel:[0,1,0] op_sel_hi:[1,1,0]
    v_fma_mix_f32 v97, v65, v92, s28 op_sel:[1,1,0] op_sel_hi:[1,1,0]
    ds_add_u64 v93, v[96:97] offset:50000
    v_fma_mix_f32 v94, v64, v92, s26 op_sel:[0,1,0] op_sel_hi:[1,1,0]
    v_fma_mix_f32 v95, v64, v92, s28 op_sel:[1,1,0] op_sel_hi:[1,1,0]
    ds_add_u64 v93, v[94:95]
    s_mov_b64 exec, -1
    v_and_b32_sdwa v92, v10, v103 dst_sel:DWORD dst_unused:UNUSED_PAD src0_sel:WORD_0 src1_sel:DWORD
    v_sub_u32_sdwa v100, v10, v10 dst_sel:DWORD dst_unused:UNUSED_PAD src0_sel:WORD_1 src1_sel:WORD_0
    v_add_u32 v92, v92, v1
    v_sub_u32_sdwa v99, v92, v10 dst_sel:DWORD dst_unused:UNUSED_PAD src0_sel:DWORD src1_sel:WORD_0
    v_mad_i32_i24 v98, v92, s51, v5
    v_cmp_lt_u32 s[90:91], v99, v100
    v_add_u32 v99, s52, v99
    v_cmp_lt_u32 s[92:93], v99, v100
    v_add_u32 v99, s52, v99
    v_cmp_lt_u32 s[94:95], v99, v100
    s_or_b64 vcc, s[90:91], s[92:93]
    s_or_b64 vcc, vcc, s[94:95]
    s_or_b64 exec, vcc, 1
    buffer_load_dwordx4 v[50:53], v98, s[12:15], 0 offen
    s_mov_b64 exec, -1
    s_add_u32 s47, s46, 2
    v_cmp_eq_u32 vcc, s47, v105
    s_or_b64 exec, vcc, s[48:49]
    buffer_load_dwordx4 v[106:109], v104, s[12:15], 0 offen
    s_mov_b64 exec, s[62:63]
    v_lshlrev_b32_sdwa v92, v102, v33 dst_sel:DWORD dst_unused:UNUSED_PAD src0_sel:DWORD src1_sel:BYTE_1
    v_bfe_u32 v93, v31, 13, 13
    v_and_or_b32 v92, v31, s35, v92
    v_lshl_add_u32 v93, v93, 3, s31
    v_fma_mix_f32 v96, v67, v92, s28 op_sel:[0,1,0] op_sel_hi:[1,1,0]
    v_fma_mix_f32 v97, v67, v92, s28 op_sel:[1,1,0] op_sel_hi:[1,1,0]
    ds_add_u64 v93, v[96:97] offset:50000
    v_fma_mix_f32 v94, v66, v92, s26 op_sel:[0,1,0] op_sel_hi:[1,1,0]
    v_fma_mix_f32 v95, v66, v92, s28 op_sel:[1,1,0] op_sel_hi:[1,1,0]
    ds_add_u64 v93, v[94:95]
    s_mov_b64 exec, s[64:65]
    v_lshlrev_b32_sdwa v92, v102, v33 dst_sel:DWORD dst_unused:UNUSED_PAD src0_sel:DWORD src1_sel:BYTE_2
    v_bfe_u32 v93, v32, 13, 13
    v_and_or_b32 v92, v32, s35, v92
    v_lshl_add_u32 v93, v93, 3, s31
    v_fma_mix_f32 v96, v69, v92, s28 op_sel:[0,1,0] op_sel_hi:[1,1,0]
    v_fma_mix_f32 v97, v69, v92, s28 op_sel:[1,1,0] op_sel_hi:[1,1,0]
    ds_add_u64 v93, v[96:97] offset:50000
    v_fma_mix_f32 v94, v68, v92, s26 op_sel:[0,1,0] op_sel_hi:[1,1,0]
    v_fma_mix_f32 v95, v68, v92, s28 op_sel:[1,1,0] op_sel_hi:[1,1,0]
    ds_add_u64 v93, v[94:95]
    s_mov_b64 exec, -1
    v_lshlrev_b32_sdwa v70, v116, v38 dst_sel:WORD_0 dst_unused:UNUSED_PAD src0_sel:DWORD src1_sel:DWORD
    v_lshlrev_b32_sdwa v72, v116, v39 dst_sel:WORD_0 dst_unused:UNUSED_PAD src0_sel:DWORD src1_sel:DWORD
    v_lshlrev_b32_sdwa v74, v116, v40 dst_sel:WORD_0 dst_unused:UNUSED_PAD src0_sel:DWORD src1_sel:DWORD
    s_mov_b64 exec, s[72:73]
    ds_read_b64 v[70:71], v70
    s_mov_b64 exec, s[74:75]
    ds_read_b64 v[72:73], v72
    s_mov_b64 exec, s[76:77]
    ds_read_b64 v[74:75], v74
    s_waitcnt vmcnt(3) lgkmcnt(0)
    s_barrier
    s_cmp_eq_u32 s33, 3
    s_cbranch_scc1 Q_LAST
    s_mov_b64 exec, -1
    ds_write_addtid_b32 v76 offset:0
    ds_write_addtid_b32 v77 offset:256
    ds_write_addtid_b32 v78 offset:512
    ds_write_addtid_b32 v79 offset:768
    ds_write_addtid_b32 v80 offset:16384
    ds_write_addtid_b32 v81 offset:16640
    ds_write_addtid_b32 v82 offset:16896
    ds_write_addtid_b32 v83 offset:17152
    ds_write_addtid_b32 v84 offset:32768
    ds_write_addtid_b32 v85 offset:33024
    ds_write_addtid_b32 v86 offset:33280
    ds_write_addtid_b32 v87 offset:33536
    s_cmp_ge_u32 s50, 8192
    s_cbranch_scc1 Q_F_39
    ds_write_addtid_b32 v88 offset:49152
    ds_write_addtid_b32 v89 offset:49408
    ds_write_addtid_b32 v90 offset:49664
    ds_write_addtid_b32 v91 offset:49920
Q_F_39:
    s_mov_b64 exec, -1
    s_cmp_ge_u32 s50, 8192
    s_cbranch_scc1 Q_C_40
    s_add_u32 s21, s20, 49152
    buffer_load_dwordx4 v[88:91], v2, s[12:15], s21 offen
Q_C_40:
    s_add_u32 s21, s20, 0
    buffer_load_dwordx4 v[76:79], v2, s[12:15], s21 offen
    s_add_u32 s21, s20, 16384
    buffer_load_dwordx4 v[80:83], v2, s[12:15], s21 offen
    s_add_u32 s21, s20, 32768
    buffer_load_dwordx4 v[84:87], v2, s[12:15], s21 offen
    s_add_u32 s20, s20, 57344
    s_mov_b64 exec, s[66:67]
    v_lshlrev_b32_sdwa v92, v102, v37 dst_sel:DWORD dst_unused:UNUSED_PAD src0_sel:DWORD src1_sel:BYTE_0
    v_bfe_u32 v93, v34, 13, 13
    v_and_or_b32 v92, v34, s35, v92
    v_lshl_add_u32 v93, v93, 3, s31
    v_fma_mix_f32 v96, v59, v92, s28 op_sel:[0,1,0] op_sel_hi:[1,1,0]
    v_fma_mix_f32 v97, v59, v92, s28 op_sel:[1,1,0] op_sel_hi:[1,1,0]
    s_waitcnt lgkmcnt(0)
    ds_add_u64 v93, v[96:97] offset:50000
    v_fma_mix_f32 v94, v58, v92, s26 op_sel:[0,1,0] op_sel_hi:[1,1,0]
    v_fma_mix_f32 v95, v58, v92, s28 op_sel:[1,1,0] op_sel_hi:[1,1,0]
    ds_add_u64 v93, v[94:95]
    s_mov_b64 exec, s[68:69]
    v_lshlrev_b32_sdwa v92, v102, v37 dst_sel:DWORD dst_unused:UNUSED_PAD src0_sel:DWORD src1_sel:BYTE_1
    v_bfe_u32 v93, v35, 13, 13
    v_and_or_b32 v92, v35, s35, v92
    v_lshl_add_u32 v93, v93, 3, s31
    v_fma_mix_f32 v96, v61, v92, s28 op_sel:[0,1,0] op_sel_hi:[1,1,0]
    v_fma_mix_f32 v97, v61, v92, s28 op_sel:[1,1,0] op_sel_hi:[1,1,0]
    ds_add_u64 v93, v[96:97] offset:50000
    v_fma_mix_f32 v94, v60, v92, s26 op_sel:[0,1,0] op_sel_hi:[1,1,0]
    v_fma_mix_f32 v95, v60, v92, s28 op_sel:[1,1,0] op_sel_hi:[1,1,0]
    ds_add_u64 v93, v[94:95]
    s_mov_b64 exec, s[70:71]
    v_lshlrev_b32_sdwa v92, v102, v37 dst_sel:DWORD dst_unused:UNUSED_PAD src0_sel:DWORD src1_sel:BYTE_2
    v_bfe_u32 v93, v36, 13, 13
    v_and_or_b32 v92, v36, s35, v92
    v_lshl_add_u32 v93, v93, 3, s31
    v_fma_mix_f32 v96, v63, v92, s28 op_sel:[0,1,0] op_sel_hi:[1,1,0]
    v_fma_mix_f32 v97, v63, v92, s28 op_sel:[1,1,0] op_sel_hi:[1,1,0]
    ds_add_u64 v93, v[96:97] offset:50000
    v_fma_mix_f32 v94, v62, v92, s26 op_sel:[0,1,0] op_sel_hi:[1,1,0]
    v_fma_mix_f32 v95, v62, v92, s28 op_sel:[1,1,0] op_sel_hi:[1,1,0]
    ds_add_u64 v93, v[94:95]
    s_waitcnt vmcnt(3)
    s_barrier
    s_mov_b64 exec, -1
    v_lshlrev_b32_sdwa v58, v116, v42 dst_sel:WORD_0 dst_unused:UNUSED_PAD src0_sel:DWORD src1_sel:DWORD
    v_lshlrev_b32_sdwa v60, v116, v43 dst_sel:WORD_0 dst_unused:UNUSED_PAD src0_sel:DWORD src1_sel:DWORD
    v_lshlrev_b32_sdwa v62, v116, v44 dst_sel:WORD_0 dst_unused:UNUSED_PAD src0_sel:DWORD src1_sel:DWORD
    s_mov_b64 exec, s[78:79]
    ds_read_b64 v[58:59], v58
    s_mov_b64 exec, s[80:81]
    ds_read_b64 v[60:61], v60
    s_mov_b64 exec, s[82:83]
    ds_read_b64 v[62:63], v62
    s_mov_b64 exec, -1
    s_add_u32 s47, s46, 2
    v_cmpx_eq_u32 vcc, s47, v105
    v_lshlrev_b32_sdwa v110, v116, v106 dst_sel:WORD_0 dst_unused:UNUSED_PAD src0_sel:DWORD src1_sel:DWORD
    v_lshlrev_b32_sdwa v112, v116, v107 dst_sel:WORD_0 dst_unused:UNUSED_PAD src0_sel:DWORD src1_sel:DWORD
    v_lshlrev_b32_sdwa v114, v116, v108 dst_sel:WORD_0 dst_unused:UNUSED_PAD src0_sel:DWORD src1_sel:DWORD
    s_and_b64 exec, vcc, s[40:41]
    ds_read_b64 v[110:111], v110
    s_and_b64 exec, vcc, s[42:43]
    ds_read_b64 v[112:113], v112
    s_and_b64 exec, vcc, s[44:45]
    ds_read_b64 v[114:115], v114
    s_mov_b64 exec, -1
    v_and_b32_sdwa v92, v19, v103 dst_sel:DWORD dst_unused:UNUSED_PAD src0_sel:WORD_0 src1_sel:DWORD
    v_sub_u32_sdwa v100, v19, v19 dst_sel:DWORD dst_unused:UNUSED_PAD src0_sel:WORD_1 src1_sel:WORD_0
    v_add_u32 v92, v92, v1
    v_sub_u32_sdwa v99, v92, v19 dst_sel:DWORD dst_unused:UNUSED_PAD src0_sel:DWORD src1_sel:WORD_0
    v_mad_i32_i24 v98, v92, s51, v6
    v_cmp_lt_u32 s[96:97], v99, v100
    v_add_u32 v99, s52, v99
    v_cmp_lt_u32 s[98:99], v99, v100
    v_add_u32 v99, s52, v99
    v_cmp_lt_u32 s[100:101], v99, v100
    s_or_b64 vcc, s[96:97], s[98:99]
    s_or_b64 vcc, vcc, s[100:101]
    s_or_b64 exec, vcc, 1
    buffer_load_dwordx4 v[54:57], v98, s[12:15], 0 offen
    s_mov_b64 exec, s[72:73]
    v_lshlrev_b32_sdwa v92, v102, v41 dst_sel:DWORD dst_unused:UNUSED_PAD src0_sel:DWORD src1_sel:BYTE_0
    v_bfe_u32 v93, v38, 13, 13
    v_and_or_b32 v92, v38, s35, v92
    v_lshl_add_u32 v93, v93, 3, s31
    v_fma_mix_f32 v96, v71, v92, s28 op_sel:[0,1,0] op_sel_hi:[1,1,0]
    v_fma_mix_f32 v97, v71, v92, s28 op_sel:[1,1,0] op_sel_hi:[1,1,0]
    ds_add_u64 v93, v[96:97] offset:50000
    v_fma_mix_f32 v94, v70, v92, s26 op_sel:[0,1,0] op_sel_hi:[1,1,0]
    v_fma_mix_f32 v95, v70, v92, s28 op_sel:[1,1,0] op_sel_hi:[1,1,0]
    ds_add_u64 v93, v[94:95]
    s_mov_b64 exec, -1
    v_and_b32_sdwa v92, v19, v103 dst_sel:DWORD dst_unused:UNUSED_PAD src0_sel:WORD_1 src1_sel:DWORD
    v_sub_u32_sdwa v100, v20, v19 dst_sel:DWORD dst_unused:UNUSED_PAD src0_sel:WORD_0 src1_sel:WORD_1
    v_add_u32 v92, v92, v1
    v_sub_u32_sdwa v99, v92, v19 dst_sel:DWORD dst_unused:UNUSED_PAD src0_sel:DWORD src1_sel:WORD_1
    v_mad_i32_i24 v98, v92, s51, v6
    v_cmp_lt_u32 s[60:61], v99, v100
    v_add_u32 v99, s52, v99
    v_cmp_lt_u32 s[62:63], v99, v100
    v_add_u32 v99, s52, v99
    v_cmp_lt_u32 s[64:65], v99, v100
    s_or_b64 vcc, s[60:61], s[62:63]
    s_or_b64 vcc, vcc, s[64:65]
    s_or_b64 exec, vcc, 1
    buffer_load_dwordx4 v[30:33], v98, s[12:15], 0 offen
    s_mov_b64 exec, -1
    s_add_u32 s47, s46, 3
    v_cmp_eq_u32 vcc, s47, v105
    s_or_b64 exec, vcc, s[48:49]
    buffer_load_dwordx4 v[106:109], v104, s[12:15], 0 offen
    s_mov_b64 exec, s[74:75]
    v_lshlrev_b32_sdwa v92, v102, v41 dst_sel:DWORD dst_unused:UNUSED_PAD src0_sel:DWORD src1_sel:BYTE_1
    v_bfe_u32 v93, v39, 13, 13
    v_and_or_b32 v92, v39, s35, v92
    v_lshl_add_u32 v93, v93, 3, s31
    v_fma_mix_f32 v96, v73, v92, s28 op_sel:[0,1,0] op_sel_hi:[1,1,0]
    v_fma_mix_f32 v97, v73, v92, s28 op_sel:[1,1,0] op_sel_hi:[1,1,0]
    ds_add_u64 v93, v[96:97] offset:50000
    v_fma_mix_f32 v94, v72, v92, s26 op_sel:[0,1,0] op_sel_hi:[1,1,0]
    v_fma_mix_f32 v95, v72, v92, s28 op_sel:[1,1,0] op_sel_hi:[1,1,0]
    ds_add_u64 v93, v[94:95]
    s_mov_b64 exec, s[76:77]
    v_lshlrev_b32_sdwa v92, v102, v41 dst_sel:DWORD dst_unused:UNUSED_PAD src0_sel:DWORD src1_sel:BYTE_2
    v_bfe_u32 v93, v40, 13, 13
    v_and_or_b32 v92, v40, s35, v92
    v_lshl_add_u32 v93, v93, 3, s31
    v_fma_mix_f32 v96, v75, v92, s28 op_sel:[0,1,0] op_sel_hi:[1,1,0]
    v_fma_mix_f32 v97, v75, v92, s28 op_sel:[1,1,0] op_sel_hi:[1,1,0]
    ds_add_u64 v93, v[96:97] offset:50000
    v_fma_mix_f32 v94, v74, v92, s26 op_sel:[0,1,0] op_sel_hi:[1,1,0]
    v_fma_mix_f32 v95, v74, v92, s28 op_sel:[1,1,0] op_sel_hi:[1,1,0]
    ds_add_u64 v93, v[94:95]
    s_mov_b64 exec, -1
    v_lshlrev_b32_sdwa v64, v116, v46 dst_sel:WORD_0 dst_unused:UNUSED_PAD src0_sel:DWORD src1_sel:DWORD
    v_lshlrev_b32_sdwa v66, v116, v47 dst_sel:WORD_0 dst_unused:UNUSED_PAD src0_sel:DWORD src1_sel:DWORD
    v_lshlrev_b32_sdwa v68, v116, v48 dst_sel:WORD_0 dst_unused:UNUSED_PAD src0_sel:DWORD src1_sel:DWORD
    s_mov_b64 exec, s[84:85]
    ds_read_b64 v[64:65], v64
    s_mov_b64 exec, s[86:87]
    ds_read_b64 v[66:67], v66
    s_mov_b64 exec, s[88:89]
    ds_read_b64 v[68:69], v68
    s_waitcnt vmcnt(3) lgkmcnt(0)
    s_barrier
    s_mov_b64 exec, -1
    ds_write_addtid_b32 v76 offset:0
    ds_write_addtid_b32 v77 offset:256
    ds_write_addtid_b32 v78 offset:512
    ds_write_addtid_b32 v79 offset:768
    ds_write_addtid_b32 v80 offset:16384
    ds_write_addtid_b32 v81 offset:16640
    ds_write_addtid_b32 v82 offset:16896
    ds_write_addtid_b32 v83 offset:17152
    ds_write_addtid_b32 v84 offset:32768
    ds_write_addtid_b32 v85 offset:33024
    ds_write_addtid_b32 v86 offset:33280
    ds_write_addtid_b32 v87 offset:33536
    s_cmp_ge_u32 s50, 8192
    s_cbranch_scc1 Q_F_41
    ds_write_addtid_b32 v88 offset:49152
    ds_write_addtid_b32 v89 offset:49408
    ds_write_addtid_b32 v90 offset:49664
    ds_write_addtid_b32 v91 offset:49920
Q_F_41:
    s_mov_b64 exec, -1
    s_cmp_ge_u32 s50, 8192
    s_cbranch_scc1 Q_C_42
    s_add_u32 s21, s20, 49152
    buffer_load_dwordx4 v[88:91], v2, s[12:15], s21 offen
Q_C_42:
    s_add_u32 s21, s20, 0
    buffer_load_dwordx4 v[76:79], v2, s[12:15], s21 offen
    s_add_u32 s21, s20, 16384
    buffer_load_dwordx4 v[80:83], v2, s[12:15], s21 offen
    s_add_u32 s21, s20, 32768
    buffer_load_dwordx4 v[84:87], v2, s[12:15], s21 offen
    s_add_u32 s20, s20, 57344
    s_mov_b64 exec, s[78:79]
    v_lshlrev_b32_sdwa v92, v102, v45 dst_sel:DWORD dst_unused:UNUSED_PAD src0_sel:DWORD src1_sel:BYTE_0
    v_bfe_u32 v93, v42, 13, 13
    v_and_or_b32 v92, v42, s35, v92
    v_lshl_add_u32 v93, v93, 3, s31
    v_fma_mix_f32 v96, v59, v92, s28 op_sel:[0,1,0] op_sel_hi:[1,1,0]
    v_fma_mix_f32 v97, v59, v92, s28 op_sel:[1,1,0] op_sel_hi:[1,1,0]
    s_waitcnt lgkmcnt(0)
    ds_add_u64 v93, v[96:97] offset:50000
    v_fma_mix_f32 v94, v58, v92, s26 op_sel:[0,1,0] op_sel_hi:[1,1,0]
    v_fma_mix_f32 v95, v58, v92, s28 op_sel:[1,1,0] op_sel_hi:[1,1,0]
    ds_add_u64 v93, v[94:95]
    s_mov_b64 exec, s[80:81]
    v_lshlrev_b32_sdwa v92, v102, v45 dst_sel:DWORD dst_unused:UNUSED_PAD src0_sel:DWORD src1_sel:BYTE_1
    v_bfe_u32 v93, v43, 13, 13
    v_and_or_b32 v92, v43, s35, v92
    v_lshl_add_u32 v93, v93, 3, s31
    v_fma_mix_f32 v96, v61, v92, s28 op_sel:[0,1,0] op_sel_hi:[1,1,0]
    v_fma_mix_f32 v97, v61, v92, s28 op_sel:[1,1,0] op_sel_hi:[1,1,0]
    ds_add_u64 v93, v[96:97] offset:50000
    v_fma_mix_f32 v94, v60, v92, s26 op_sel:[0,1,0] op_sel_hi:[1,1,0]
    v_fma_mix_f32 v95, v60, v92, s28 op_sel:[1,1,0] op_sel_hi:[1,1,0]
    ds_add_u64 v93, v[94:95]
    s_mov_b64 exec, s[82:83]
    v_lshlrev_b32_sdwa v92, v102, v45 dst_sel:DWORD dst_unused:UNUSED_PAD src0_sel:DWORD src1_sel:BYTE_2
    v_bfe_u32 v93, v44, 13, 13
    v_and_or_b32 v92, v44, s35, v92
    v_lshl_add_u32 v93, v93, 3, s31
    v_fma_mix_f32 v96, v63, v92, s28 op_sel:[0,1,0] op_sel_hi:[1,1,0]
    v_fma_mix_f32 v97, v63, v92, s28 op_sel:[1,1,0] op_sel_hi:[1,1,0]
    ds_add_u64 v93, v[96:97] offset:50000
    v_fma_mix_f32 v94, v62, v92, s26 op_sel:[0,1,0] op_sel_hi:[1,1,0]
    v_fma_mix_f32 v95, v62, v92, s28 op_sel:[1,1,0] op_sel_hi:[1,1,0]
    ds_add_u64 v93, v[94:95]
    s_waitcnt vmcnt(3)
    s_barrier
    s_mov_b64 exec, -1
    v_lshlrev_b32_sdwa v58, v116, v50 dst_sel:WORD_0 dst_unused:UNUSED_PAD src0_sel:DWORD src1_sel:DWORD
    v_lshlrev_b32_sdwa v60, v116, v51 dst_sel:WORD_0 dst_unused:UNUSED_PAD src0_sel:DWORD src1_sel:DWORD
    v_lshlrev_b32_sdwa v62, v116, v52 dst_sel:WORD_0 dst_unused:UNUSED_PAD src0_sel:DWORD src1_sel:DWORD
    s_mov_b64 exec, s[90:91]
    ds_read_b64 v[58:59], v58
    s_mov_b64 exec, s[92:93]
    ds_read_b64 v[60:61], v60
    s_mov_b64 exec, s[94:95]
    ds_read_b64 v[62:63], v62
    s_mov_b64 exec, -1
    s_add_u32 s47, s46, 3
    v_cmpx_eq_u32 vcc, s47, v105
    v_lshlrev_b32_sdwa v110, v116, v106 dst_sel:WORD_0 dst_unused:UNUSED_PAD src0_sel:DWORD src1_sel:DWORD
    v_lshlrev_b32_sdwa v112, v116, v107 dst_sel:WORD_0 dst_unused:UNUSED_PAD src0_sel:DWORD src1_sel:DWORD
    v_lshlrev_b32_sdwa v114, v116, v108 dst_sel:WORD_0 dst_unused:UNUSED_PAD src0_sel:DWORD src1_sel:DWORD
    s_and_b64 exec, vcc, s[40:41]
    ds_read_b64 v[110:111], v110
    s_and_b64 exec, vcc, s[42:43]
    ds_read_b64 v[112:113], v112
    s_and_b64 exec, vcc, s[44:45]
    ds_read_b64 v[114:115], v114
    s_mov_b64 exec, -1
    v_and_b32_sdwa v92, v10, v103 dst_sel:DWORD dst_unused:UNUSED_PAD src0_sel:WORD_1 src1_sel:DWORD
    v_sub_u32_sdwa v100, v11, v10 dst_sel:DWORD dst_unused:UNUSED_PAD src0_sel:WORD_0 src1_sel:WORD_1
    v_add_u32 v92, v92, v1
    v_sub_u32_sdwa v99, v92, v10 dst_sel:DWORD dst_unused:UNUSED_PAD src0_sel:DWORD src1_sel:WORD_1
    v_mad_i32_i24 v98, v92, s51, v5
    v_cmp_lt_u32 s[54:55], v99, v100
    v_add_u32 v99, s52, v99
    v_cmp_lt_u32 s[56:57], v99, v100
    v_add_u32 v99, s52, v99
    v_cmp_lt_u32 s[58:59], v99, v100
    s_or_b64 vcc, s[54:55], s[56:57]
    s_or_b64 vcc, vcc, s[58:59]
    s_or_b64 exec, vcc, 1
    buffer_load_dwordx4 v[26:29], v98, s[12:15], 0 offen
    s_mov_b64 exec, s[84:85]
    v_lshlrev_b32_sdwa v92, v102, v49 dst_sel:DWORD dst_unused:UNUSED_PAD src0_sel:DWORD src1_sel:BYTE_0
    v_bfe_u32 v93, v46, 13, 13
    v_and_or_b32 v92, v46, s35, v92
    v_lshl_add_u32 v93, v93, 3, s31
    v_fma_mix_f32 v96, v65, v92, s28 op_sel:[0,1,0] op_sel_hi:[1,1,0]
    v_fma_mix_f32 v97, v65, v92, s28 op_sel:[1,1,0] op_sel_hi:[1,1,0]
    ds_add_u64 v93, v[96:97] offset:50000
    v_fma_mix_f32 v94, v64, v92, s26 op_sel:[0,1,0] op_sel_hi:[1,1,0]
    v_fma_mix_f32 v95, v64, v92, s28 op_sel:[1,1,0] op_sel_hi:[1,1,0]
    ds_add_u64 v93, v[94:95]
    s_mov_b64 exec, -1
    v_and_b32_sdwa v92, v11, v103 dst_sel:DWORD dst_unused:UNUSED_PAD src0_sel:WORD_0 src1_sel:DWORD
    v_sub_u32_sdwa v100, v11, v11 dst_sel:DWORD dst_unused:UNUSED_PAD src0_sel:WORD_1 src1_sel:WORD_0
    v_add_u32 v92, v92, v1
    v_sub_u32_sdwa v99, v92, v11 dst_sel:DWORD dst_unused:UNUSED_PAD src0_sel:DWORD src1_sel:WORD_0
    v_mad_i32_i24 v98, v92, s51, v5
    v_cmp_lt_u32 s[66:67], v99, v100
    v_add_u32 v99, s52, v99
    v_cmp_lt_u32 s[68:69], v99, v100
    v_add_u32 v99, s52, v99
    v_cmp_lt_u32 s[70:71], v99, v100
    s_or_b64 vcc, s[66:67], s[68:69]
    s_or_b64 vcc, vcc, s[70:71]
    s_or_b64 exec, vcc, 1
    buffer_load_dwordx4 v[34:37], v98, s[12:15], 0 offen
    s_mov_b64 exec, -1
    s_add_u32 s47, s46, 4
    v_cmp_eq_u32 vcc, s47, v105
    s_or_b64 exec, vcc, s[48:49]
    buffer_load_dwordx4 v[106:109], v104, s[12:15], 0 offen
    s_mov_b64 exec, s[86:87]
    v_lshlrev_b32_sdwa v92, v102, v49 dst_sel:DWORD dst_unused:UNUSED_PAD src0_sel:DWORD src1_sel:BYTE_1
    v_bfe_u32 v93, v47, 13, 13
    v_and_or_b32 v92, v47, s35, v92
    v_lshl_add_u32 v93, v93, 3, s31
    v_fma_mix_f32 v96, v67, v92, s28 op_sel:[0,1,0] op_sel_hi:[1,1,0]
    v_fma_mix_f32 v97, v67, v92, s28 op_sel:[1,1,0] op_sel_hi:[1,1,0]
    ds_add_u64 v93, v[96:97] offset:50000
    v_fma_mix_f32 v94, v66, v92, s26 op_sel:[0,1,0] op_sel_hi:[1,1,0]
    v_fma_mix_f32 v95, v66, v92, s28 op_sel:[1,1,0] op_sel_hi:[1,1,0]
    ds_add_u64 v93, v[94:95]
    s_mov_b64 exec, s[88:89]
    v_lshlrev_b32_sdwa v92, v102, v49 dst_sel:DWORD dst_unused:UNUSED_PAD src0_sel:DWORD src1_sel:BYTE_2
    v_bfe_u32 v93, v48, 13, 13
    v_and_or_b32 v92, v48, s35, v92
    v_lshl_add_u32 v93, v93, 3, s31
    v_fma_mix_f32 v96, v69, v92, s28 op_sel:[0,1,0] op_sel_hi:[1,1,0]
    v_fma_mix_f32 v97, v69, v92, s28 op_sel:[1,1,0] op_sel_hi:[1,1,0]
    ds_add_u64 v93, v[96:97] offset:50000
    v_fma_mix_f32 v94, v68, v92, s26 op_sel:[0,1,0] op_sel_hi:[1,1,0]
    v_fma_mix_f32 v95, v68, v92, s28 op_sel:[1,1,0] op_sel_hi:[1,1,0]
    ds_add_u64 v93, v[94:95]
    s_mov_b64 exec, -1
    v_lshlrev_b32_sdwa v70, v116, v54 dst_sel:WORD_0 dst_unused:UNUSED_PAD src0_sel:DWORD src1_sel:DWORD
    v_lshlrev_b32_sdwa v72, v116, v55 dst_sel:WORD_0 dst_unused:UNUSED_PAD src0_sel:DWORD src1_sel:DWORD
    v_lshlrev_b32_sdwa v74, v116, v56 dst_sel:WORD_0 dst_unused:UNUSED_PAD src0_sel:DWORD src1_sel:DWORD
    s_mov_b64 exec, s[96:97]
    ds_read_b64 v[70:71], v70
    s_mov_b64 exec, s[98:99]
    ds_read_b64 v[72:73], v72
    s_mov_b64 exec, s[100:101]
    ds_read_b64 v[74:75], v74
    s_waitcnt vmcnt(3) lgkmcnt(0)
    s_barrier
    s_mov_b64 exec, -1
    ds_write_addtid_b32 v76 offset:0
    ds_write_addtid_b32 v77 offset:256
    ds_write_addtid_b32 v78 offset:512
    ds_write_addtid_b32 v79 offset:768
    ds_write_addtid_b32 v80 offset:16384
    ds_write_addtid_b32 v81 offset:16640
    ds_write_addtid_b32 v82 offset:16896
    ds_write_addtid_b32 v83 offset:17152
    ds_write_addtid_b32 v84 offset:32768
    ds_write_addtid_b32 v85 offset:33024
    ds_write_addtid_b32 v86 offset:33280
    ds_write_addtid_b32 v87 offset:33536
    s_cmp_ge_u32 s50, 8192
    s_cbranch_scc1 Q_F_43
    ds_write_addtid_b32 v88 offset:49152
    ds_write_addtid_b32 v89 offset:49408
    ds_write_addtid_b32 v90 offset:49664
    ds_write_addtid_b32 v91 offset:49920
Q_F_43:
    s_mov_b64 exec, -1
    s_cmp_ge_u32 s50, 8192
    s_cbranch_scc1 Q_C_44
    s_add_u32 s21, s20, 49152
    buffer_load_dwordx4 v[88:91], v2, s[12:15], s21 offen
Q_C_44:
    s_add_u32 s21, s20, 0
    buffer_load_dwordx4 v[76:79], v2, s[12:15], s21 offen
    s_add_u32 s21, s20, 16384
    buffer_load_dwordx4 v[80:83], v2, s[12:15], s21 offen
    s_add_u32 s21, s20, 32768
    buffer_load_dwordx4 v[84:87], v2, s[12:15], s21 offen
    s_add_u32 s20, s20, 57344
    s_mov_b64 exec, s[90:91]
    v_lshlrev_b32_sdwa v92, v102, v53 dst_sel:DWORD dst_unused:UNUSED_PAD src0_sel:DWORD src1_sel:BYTE_0
    v_bfe_u32 v93, v50, 13, 13
    v_and_or_b32 v92, v50, s35, v92
    v_lshl_add_u32 v93, v93, 3, s31
    v_fma_mix_f32 v96, v59, v92, s28 op_sel:[0,1,0] op_sel_hi:[1,1,0]
    v_fma_mix_f32 v97, v59, v92, s28 op_sel:[1,1,0] op_sel_hi:[1,1,0]
    s_waitcnt lgkmcnt(0)
    ds_add_u64 v93, v[96:97] offset:50000
    v_fma_mix_f32 v94, v58, v92, s26 op_sel:[0,1,0] op_sel_hi:[1,1,0]
    v_fma_mix_f32 v95, v58, v92, s28 op_sel:[1,1,0] op_sel_hi:[1,1,0]
    ds_add_u64 v93, v[94:95]
    s_mov_b64 exec, s[92:93]
    v_lshlrev_b32_sdwa v92, v102, v53 dst_sel:DWORD dst_unused:UNUSED_PAD src0_sel:DWORD src1_sel:BYTE_1
    v_bfe_u32 v93, v51, 13, 13
    v_and_or_b32 v92, v51, s35, v92
    v_lshl_add_u32 v93, v93, 3, s31
    v_fma_mix_f32 v96, v61, v92, s28 op_sel:[0,1,0] op_sel_hi:[1,1,0]
    v_fma_mix_f32 v97, v61, v92, s28 op_sel:[1,1,0] op_sel_hi:[1,1,0]
    ds_add_u64 v93, v[96:97] offset:50000
    v_fma_mix_f32 v94, v60, v92, s26 op_sel:[0,1,0] op_sel_hi:[1,1,0]
    v_fma_mix_f32 v95, v60, v92, s28 op_sel:[1,1,0] op_sel_hi:[1,1,0]
    ds_add_u64 v93, v[94:95]
    s_mov_b64 exec, s[94:95]
    v_lshlrev_b32_sdwa v92, v102, v53 dst_sel:DWORD dst_unused:UNUSED_PAD src0_sel:DWORD src1_sel:BYTE_2
    v_bfe_u32 v93, v52, 13, 13
    v_and_or_b32 v92, v52, s35, v92
    v_lshl_add_u32 v93, v93, 3, s31
    v_fma_mix_f32 v96, v63, v92, s28 op_sel:[0,1,0] op_sel_hi:[1,1,0]
    v_fma_mix_f32 v97, v63, v92, s28 op_sel:[1,1,0] op_sel_hi:[1,1,0]
    ds_add_u64 v93, v[96:97] offset:50000
    v_fma_mix_f32 v94, v62, v92, s26 op_sel:[0,1,0] op_sel_hi:[1,1,0]
    v_fma_mix_f32 v95, v62, v92, s28 op_sel:[1,1,0] op_sel_hi:[1,1,0]
    ds_add_u64 v93, v[94:95]
    s_waitcnt vmcnt(3)
    s_barrier
    s_mov_b64 exec, -1
    v_lshlrev_b32_sdwa v58, v116, v26 dst_sel:WORD_0 dst_unused:UNUSED_PAD src0_sel:DWORD src1_sel:DWORD
    v_lshlrev_b32_sdwa v60, v116, v27 dst_sel:WORD_0 dst_unused:UNUSED_PAD src0_sel:DWORD src1_sel:DWORD
    v_lshlrev_b32_sdwa v62, v116, v28 dst_sel:WORD_0 dst_unused:UNUSED_PAD src0_sel:DWORD src1_sel:DWORD
    s_mov_b64 exec, s[54:55]
    ds_read_b64 v[58:59], v58
    s_mov_b64 exec, s[56:57]
    ds_read_b64 v[60:61], v60
    s_mov_b64 exec, s[58:59]
    ds_read_b64 v[62:63], v62
    s_mov_b64 exec, -1
    s_add_u32 s47, s46, 4
    v_cmpx_eq_u32 vcc, s47, v105
    v_lshlrev_b32_sdwa v110, v116, v106 dst_sel:WORD_0 dst_unused:UNUSED_PAD src0_sel:DWORD src1_sel:DWORD
    v_lshlrev_b32_sdwa v112, v116, v107 dst_sel:WORD_0 dst_unused:UNUSED_PAD src0_sel:DWORD src1_sel:DWORD
    v_lshlrev_b32_sdwa v114, v116, v108 dst_sel:WORD_0 dst_unused:UNUSED_PAD src0_sel:DWORD src1_sel:DWORD
    s_and_b64 exec, vcc, s[40:41]
    ds_read_b64 v[110:111], v110
    s_and_b64 exec, vcc, s[42:43]
    ds_read_b64 v[112:113], v112
    s_and_b64 exec, vcc, s[44:45]
    ds_read_b64 v[114:115], v114
    s_mov_b64 exec, -1
    v_and_b32_sdwa v92, v20, v103 dst_sel:DWORD dst_unused:UNUSED_PAD src0_sel:WORD_0 src1_sel:DWORD
    v_sub_u32_sdwa v100, v20, v20 dst_sel:DWORD dst_unused:UNUSED_PAD src0_sel:WORD_1 src1_sel:WORD_0
    v_add_u32 v92, v92, v1
    v_sub_u32_sdwa v99, v92, v20 dst_sel:DWORD dst_unused:UNUSED_PAD src0_sel:DWORD src1_sel:WORD_0
    v_mad_i32_i24 v98, v92, s51, v6
    v_cmp_lt_u32 s[72:73], v99, v100
    v_add_u32 v99, s52, v99
    v_cmp_lt_u32 s[74:75], v99, v100
    v_add_u32 v99, s52, v99
    v_cmp_lt_u32 s[76:77], v99, v100
    s_or_b64 vcc, s[72:73], s[74:75]
    s_or_b64 vcc, vcc, s[76:77]
    s_or_b64 exec, vcc, 1
    buffer_load_dwordx4 v[38:41], v98, s[12:15], 0 offen
    s_mov_b64 exec, s[96:97]
    v_lshlrev_b32_sdwa v92, v102, v57 dst_sel:DWORD dst_unused:UNUSED_PAD src0_sel:DWORD src1_sel:BYTE_0
    v_bfe_u32 v93, v54, 13, 13
    v_and_or_b32 v92, v54, s35, v92
    v_lshl_add_u32 v93, v93, 3, s31
    v_fma_mix_f32 v96, v71, v92, s28 op_sel:[0,1,0] op_sel_hi:[1,1,0]
    v_fma_mix_f32 v97, v71, v92, s28 op_sel:[1,1,0] op_sel_hi:[1,1,0]
    ds_add_u64 v93, v[96:97] offset:50000
    v_fma_mix_f32 v94, v70, v92, s26 op_sel:[0,1,0] op_sel_hi:[1,1,0]
    v_fma_mix_f32 v95, v70, v92, s28 op_sel:[1,1,0] op_sel_hi:[1,1,0]
    ds_add_u64 v93, v[94:95]
    s_mov_b64 exec, -1
    v_and_b32_sdwa v92, v20, v103 dst_sel:DWORD dst_unused:UNUSED_PAD src0_sel:WORD_1 src1_sel:DWORD
    v_sub_u32_sdwa v100, v21, v20 dst_sel:DWORD dst_unused:UNUSED_PAD src0_sel:WORD_0 src1_sel:WORD_1
    v_add_u32 v92, v92, v1
    v_sub_u32_sdwa v99, v92, v20 dst_sel:DWORD dst_unused:UNUSED_PAD src0_sel:DWORD src1_sel:WORD_1
    v_mad_i32_i24 v98, v92, s51, v6
    v_cmp_lt_u32 s[84:85], v99, v100
    v_add_u32 v99, s52, v99
    v_cmp_lt_u32 s[86:87], v99, v100
    v_add_u32 v99, s52, v99
    v_cmp_lt_u32 s[88:89], v99, v100
    s_or_b64 vcc, s[84:85], s[86:87]
    s_or_b64 vcc, vcc, s[88:89]
    s_or_b64 exec, vcc, 1
    buffer_load_dwordx4 v[46:49], v98, s[12:15], 0 offen
    s_mov_b64 exec, -1
    s_add_u32 s47, s46, 5
    v_cmp_eq_u32 vcc, s47, v105
    s_or_b64 exec, vcc, s[48:49]
    buffer_load_dwordx4 v[106:109], v104, s[12:15], 0 offen
    s_mov_b64 exec, s[98:99]
    v_lshlrev_b32_sdwa v92, v102, v57 dst_sel:DWORD dst_unused:UNUSED_PAD src0_sel:DWORD src1_sel:BYTE_1
    v_bfe_u32 v93, v55, 13, 13
    v_and_or_b32 v92, v55, s35, v92
    v_lshl_add_u32 v93, v93, 3, s31
    v_fma_mix_f32 v96, v73, v92, s28 op_sel:[0,1,0] op_sel_hi:[1,1,0]
    v_fma_mix_f32 v97, v73, v92, s28 op_sel:[1,1,0] op_sel_hi:[1,1,0]
    ds_add_u64 v93, v[96:97] offset:50000
    v_fma_mix_f32 v94, v72, v92, s26 op_sel:[0,1,0] op_sel_hi:[1,1,0]
    v_fma_mix_f32 v95, v72, v92, s28 op_sel:[1,1,0] op_sel_hi:[1,1,0]
    ds_add_u64 v93, v[94:95]
    s_mov_b64 exec, s[100:101]
    v_lshlrev_b32_sdwa v92, v102, v57 dst_sel:DWORD dst_unused:UNUSED_PAD src0_sel:DWORD src1_sel:BYTE_2
    v_bfe_u32 v93, v56, 13, 13
    v_and_or_b32 v92, v56, s35, v92
    v_lshl_add_u32 v93, v93, 3, s31
    v_fma_mix_f32 v96, v75, v92, s28 op_sel:[0,1,0] op_sel_hi:[1,1,0]
    v_fma_mix_f32 v97, v75, v92, s28 op_sel:[1,1,0] op_sel_hi:[1,1,0]
    ds_add_u64 v93, v[96:97] offset:50000
    v_fma_mix_f32 v94, v74, v92, s26 op_sel:[0,1,0] op_sel_hi:[1,1,0]
    v_fma_mix_f32 v95, v74, v92, s28 op_sel:[1,1,0] op_sel_hi:[1,1,0]
    ds_add_u64 v93, v[94:95]
    s_mov_b64 exec, -1
    v_lshlrev_b32_sdwa v64, v116, v30 dst_sel:WORD_0 dst_unused:UNUSED_PAD src0_sel:DWORD src1_sel:DWORD
    v_lshlrev_b32_sdwa v66, v116, v31 dst_sel:WORD_0 dst_unused:UNUSED_PAD src0_sel:DWORD src1_sel:DWORD
    v_lshlrev_b32_sdwa v68, v116, v32 dst_sel:WORD_0 dst_unused:UNUSED_PAD src0_sel:DWORD src1_sel:DWORD
    s_mov_b64 exec, s[60:61]
    ds_read_b64 v[64:65], v64
    s_mov_b64 exec, s[62:63]
    ds_read_b64 v[66:67], v66
    s_mov_b64 exec, s[64:65]
    ds_read_b64 v[68:69], v68
    s_mov_b64 exec, -1
    s_add_u32 s33, s33, 1
    s_add_u32 s46, s46, 4
    v_mov_b32 v8, v10
    v_mov_b32 v9, v11
    v_mov_b32 v10, v12
    v_mov_b32 v11, v13
    v_mov_b32 v12, v14
    v_mov_b32 v13, v15
    v_mov_b32 v14, v16
    v_mov_b32 v15, v16
    v_mov_b32 v17, v19
    v_mov_b32 v18, v20
    v_mov_b32 v19, v21
    v_mov_b32 v20, v22
    v_mov_b32 v21, v23
    v_mov_b32 v22, v24
    v_mov_b32 v23, v25
    v_mov_b32 v24, v25
    s_waitcnt vmcnt(3) lgkmcnt(0)
    s_branch Q_LOOP
Q_LAST:
    s_cmp_lg_u32 s50, 0
    s_cbranch_scc1 Q_NOWARM
    s_load_dwordx2 s[4:5], s[0:1], 24
    s_load_dwordx2 s[6:7], s[0:1], 40
    s_load_dwordx8 s[56:63], s[0:1], 56
    s_mov_b64 exec, -1
    s_mul_i32 s16, s2, 3200
    v_lshl_add_u32 v92, v4, 6, s16
    v_min_u32 v92, 799996, v92
    s_waitcnt lgkmcnt(0)
    global_load_dword v76, v92, s[4:5]
    s_load_dword s16, s[6:7], 0
    s_load_dword s17, s[56:57], 0
    s_load_dword s18, s[58:59], 0
    s_load_dword s19, s[60:61], 0
    s_load_dword s20, s[62:63], 0
Q_NOWARM:
    s_mov_b64 exec, s[66:67]
    v_lshlrev_b32_sdwa v92, v102, v37 dst_sel:DWORD dst_unused:UNUSED_PAD src0_sel:DWORD src1_sel:BYTE_0
    v_bfe_u32 v93, v34, 13, 13
    v_and_or_b32 v92, v34, s35, v92
    v_lshl_add_u32 v93, v93, 3, s31
    v_fma_mix_f32 v96, v59, v92, s28 op_sel:[0,1,0] op_sel_hi:[1,1,0]
    v_fma_mix_f32 v97, v59, v92, s28 op_sel:[1,1,0] op_sel_hi:[1,1,0]
    ds_add_u64 v93, v[96:97] offset:50000
    v_fma_mix_f32 v94, v58, v92, s26 op_sel:[0,1,0] op_sel_hi:[1,1,0]
    v_fma_mix_f32 v95, v58, v92, s28 op_sel:[1,1,0] op_sel_hi:[1,1,0]
    ds_add_u64 v93, v[94:95]
    s_mov_b64 exec, s[68:69]
    v_lshlrev_b32_sdwa v92, v102, v37 dst_sel:DWORD dst_unused:UNUSED_PAD src0_sel:DWORD src1_sel:BYTE_1
    v_bfe_u32 v93, v35, 13, 13
    v_and_or_b32 v92, v35, s35, v92
    v_lshl_add_u32 v93, v93, 3, s31
    v_fma_mix_f32 v96, v61, v92, s28 op_sel:[0,1,0] op_sel_hi:[1,1,0]
    v_fma_mix_f32 v97, v61, v92, s28 op_sel:[1,1,0] op_sel_hi:[1,1,0]
    ds_add_u64 v93, v[96:97] offset:50000
    v_fma_mix_f32 v94, v60, v92, s26 op_sel:[0,1,0] op_sel_hi:[1,1,0]
    v_fma_mix_f32 v95, v60, v92, s28 op_sel:[1,1,0] op_sel_hi:[1,1,0]
    ds_add_u64 v93, v[94:95]
    s_mov_b64 exec, s[70:71]
    v_lshlrev_b32_sdwa v92, v102, v37 dst_sel:DWORD dst_unused:UNUSED_PAD src0_sel:DWORD src1_sel:BYTE_2
    v_bfe_u32 v93, v36, 13, 13
    v_and_or_b32 v92, v36, s35, v92
    v_lshl_add_u32 v93, v93, 3, s31
    v_fma_mix_f32 v96, v63, v92, s28 op_sel:[0,1,0] op_sel_hi:[1,1,0]
    v_fma_mix_f32 v97, v63, v92, s28 op_sel:[1,1,0] op_sel_hi:[1,1,0]
    ds_add_u64 v93, v[96:97] offset:50000
    v_fma_mix_f32 v94, v62, v92, s26 op_sel:[0,1,0] op_sel_hi:[1,1,0]
    v_fma_mix_f32 v95, v62, v92, s28 op_sel:[1,1,0] op_sel_hi:[1,1,0]
    ds_add_u64 v93, v[94:95]
    s_mov_b64 exec, s[72:73]
    v_lshlrev_b32_sdwa v92, v102, v41 dst_sel:DWORD dst_unused:UNUSED_PAD src0_sel:DWORD src1_sel:BYTE_0
    v_bfe_u32 v93, v38, 13, 13
    v_and_or_b32 v92, v38, s35, v92
    v_lshl_add_u32 v93, v93, 3, s31
    v_fma_mix_f32 v96, v71, v92, s28 op_sel:[0,1,0] op_sel_hi:[1,1,0]
    v_fma_mix_f32 v97, v71, v92, s28 op_sel:[1,1,0] op_sel_hi:[1,1,0]
    ds_add_u64 v93, v[96:97] offset:50000
    v_fma_mix_f32 v94, v70, v92, s26 op_sel:[0,1,0] op_sel_hi:[1,1,0]
    v_fma_mix_f32 v95, v70, v92, s28 op_sel:[1,1,0] op_sel_hi:[1,1,0]
    ds_add_u64 v93, v[94:95]
    s_mov_b64 exec, s[74:75]
    v_lshlrev_b32_sdwa v92, v102, v41 dst_sel:DWORD dst_unused:UNUSED_PAD src0_sel:DWORD src1_sel:BYTE_1
    v_bfe_u32 v93, v39, 13, 13
    v_and_or_b32 v92, v39, s35, v92
    v_lshl_add_u32 v93, v93, 3, s31
    v_fma_mix_f32 v96, v73, v92, s28 op_sel:[0,1,0] op_sel_hi:[1,1,0]
    v_fma_mix_f32 v97, v73, v92, s28 op_sel:[1,1,0] op_sel_hi:[1,1,0]
    ds_add_u64 v93, v[96:97] offset:50000
    v_fma_mix_f32 v94, v72, v92, s26 op_sel:[0,1,0] op_sel_hi:[1,1,0]
    v_fma_mix_f32 v95, v72, v92, s28 op_sel:[1,1,0] op_sel_hi:[1,1,0]
    ds_add_u64 v93, v[94:95]
    s_mov_b64 exec, s[76:77]
    v_lshlrev_b32_sdwa v92, v102, v41 dst_sel:DWORD dst_unused:UNUSED_PAD src0_sel:DWORD src1_sel:BYTE_2
    v_bfe_u32 v93, v40, 13, 13
    v_and_or_b32 v92, v40, s35, v92
    v_lshl_add_u32 v93, v93, 3, s31
    v_fma_mix_f32 v96, v75, v92, s28 op_sel:[0,1,0] op_sel_hi:[1,1,0]
    v_fma_mix_f32 v97, v75, v92, s28 op_sel:[1,1,0] op_sel_hi:[1,1,0]
    ds_add_u64 v93, v[96:97] offset:50000
    v_fma_mix_f32 v94, v74, v92, s26 op_sel:[0,1,0] op_sel_hi:[1,1,0]
    v_fma_mix_f32 v95, v74, v92, s28 op_sel:[1,1,0] op_sel_hi:[1,1,0]
    ds_add_u64 v93, v[94:95]
    s_waitcnt vmcnt(0)
    s_mov_b64 exec, s[40:41]
    v_lshlrev_b32_sdwa v92, v102, v109 dst_sel:DWORD dst_unused:UNUSED_PAD src0_sel:DWORD src1_sel:BYTE_0
    v_bfe_u32 v93, v106, 13, 13
    v_and_or_b32 v92, v106, s35, v92
    v_lshl_add_u32 v93, v93, 3, s31
    v_fma_mix_f32 v96, v111, v92, s28 op_sel:[0,1,0] op_sel_hi:[1,1,0]
    v_fma_mix_f32 v97, v111, v92, s28 op_sel:[1,1,0] op_sel_hi:[1,1,0]
    ds_add_u64 v93, v[96:97] offset:50000
    v_fma_mix_f32 v94, v110, v92, s26 op_sel:[0,1,0] op_sel_hi:[1,1,0]
    v_fma_mix_f32 v95, v110, v92, s28 op_sel:[1,1,0] op_sel_hi:[1,1,0]
    ds_add_u64 v93, v[94:95]
    s_mov_b64 exec, s[42:43]
    v_lshlrev_b32_sdwa v92, v102, v109 dst_sel:DWORD dst_unused:UNUSED_PAD src0_sel:DWORD src1_sel:BYTE_1
    v_bfe_u32 v93, v107, 13, 13
    v_and_or_b32 v92, v107, s35, v92
    v_lshl_add_u32 v93, v93, 3, s31
    v_fma_mix_f32 v96, v113, v92, s28 op_sel:[0,1,0] op_sel_hi:[1,1,0]
    v_fma_mix_f32 v97, v113, v92, s28 op_sel:[1,1,0] op_sel_hi:[1,1,0]
    ds_add_u64 v93, v[96:97] offset:50000
    v_fma_mix_f32 v94, v112, v92, s26 op_sel:[0,1,0] op_sel_hi:[1,1,0]
    v_fma_mix_f32 v95, v112, v92, s28 op_sel:[1,1,0] op_sel_hi:[1,1,0]
    ds_add_u64 v93, v[94:95]
    s_mov_b64 exec, s[44:45]
    v_lshlrev_b32_sdwa v92, v102, v109 dst_sel:DWORD dst_unused:UNUSED_PAD src0_sel:DWORD src1_sel:BYTE_2
    v_bfe_u32 v93, v108, 13, 13
    v_and_or_b32 v92, v108, s35, v92
    v_lshl_add_u32 v93, v93, 3, s31
    v_fma_mix_f32 v96, v115, v92, s28 op_sel:[0,1,0] op_sel_hi:[1,1,0]
    v_fma_mix_f32 v97, v115, v92, s28 op_sel:[1,1,0] op_sel_hi:[1,1,0]
    ds_add_u64 v93, v[96:97] offset:50000
    v_fma_mix_f32 v94, v114, v92, s26 op_sel:[0,1,0] op_sel_hi:[1,1,0]
    v_fma_mix_f32 v95, v114, v92, s28 op_sel:[1,1,0] op_sel_hi:[1,1,0]
    ds_add_u64 v93, v[94:95]
    s_mov_b64 exec, -1
    s_waitcnt lgkmcnt(0)
    s_barrier
    v_lshlrev_b32 v3, 3, v0
    v_add_u32 v7, 57344, v3
    ds_read_b64 v[8:9], v7 offset:0
    ds_read_b64 v[12:13], v7 offset:8192
    ds_read_b64 v[16:17], v7 offset:16384
    ds_read_b64 v[20:21], v7 offset:24576
    ds_read_b64 v[24:25], v7 offset:32768
    ds_read_b64 v[28:29], v7 offset:40960
    s_mov_b64 exec, s[24:25]
    ds_read_b64 v[32:33], v7 offset:49152
    s_mov_b64 exec, -1
    v_add_u32 v4, 50000, v7
    ds_read_b64 v[10:11], v4 offset:0
    ds_read_b64 v[14:15], v4 offset:8192
    ds_read_b64 v[18:19], v4 offset:16384
    ds_read_b64 v[22:23], v4 offset:24576
    ds_read_b64 v[26:27], v4 offset:32768
    ds_read_b64 v[30:31], v4 offset:40960
    s_mov_b64 exec, s[24:25]
    ds_read_b64 v[34:35], v4 offset:49152
    s_mov_b64 exec, -1
    s_lshr_b32 s16, s3, 6
    s_mul_i32 s16, s16, 3200000
    s_and_b32 s17, s3, 63
    s_mul_i32 s17, s17, 50000
    s_add_u32 s16, s16, s17
    s_add_u32 s16, s16, 0x5000000
    v_mov_b32 v5, 0
    s_mov_b32 s36, 0x3a800000
    s_mov_b32 s37, 0x39000000
    s_mov_b32 s38, s37
    s_mov_b32 s39, s37
    s_sub_i32 s40, s27, 135
    v_mov_b32 v6, 1.0
    v_ldexp_f32 v6, v6, s40
    s_and_b32 s41, s3, 63
    s_lshl_b32 s41, s41, 2
    s_lshr_b32 s42, s3, 6
    s_add_u32 s41, s41, s42
    s_lshl_b32 s41, s41, 2
    s_add_u32 s41, s41, 0x4c03000
    v_cmp_eq_u32 vcc, 0, v0
    s_mov_b64 exec, vcc
    buffer_store_dword v6, v5, s[12:15], s41 offen
    s_mov_b64 exec, -1
    s_mov_b32 s51, 0
    s_mov_b32 s52, 0x3e800000
    s_mov_b32 s56, 0x43800000
    s_mov_b32 s57, 0
    s_waitcnt lgkmcnt(5)
    v_lshrrev_b32 v40, 26, v8
    v_and_b32 v8, 0x3ffffff, v8
    v_mul_u32_u24 v40, 49, v40
    v_and_b32 v40, 63, v40
    v_mad_u64_u32 v[42:43], vcc, v40, s28, 0
    v_lshlrev_b32 v44, 19, v40
    v_add_u32 v5, v5, v40
    v_sub_u32 v8, v8, v44
    v_mul_u32_u24 v44, 17, v40
    v_sub_u32 v9, v9, v42
    v_lshrrev_b32 v44, 6, v44
    v_sub_u32 v9, v9, v44
    v_add_u32 v43, v43, v42
    v_sub_co_u32 v10, vcc, v10, v42
    v_cvt_f32_i32 v8, v8
    v_cvt_f32_i32 v9, v9
    v_subb_co_u32 v11, vcc, v11, v43, vcc
    v_ashrrev_i32 v44, 31, v10
    v_cvt_f32_i32 v10, v10
    v_sub_u32 v11, v11, v44
    v_min3_f32 v40, abs(v8), abs(v9), abs(v10)
    v_cvt_f32_i32 v11, v11
    v_pk_mul_f32 v[8:9], v[8:9], s[36:37]
    v_min_f32 v40, abs(v11), v40
    v_pk_mul_f32 v[10:11], v[10:11], s[38:39]
    v_max_f32 v44, abs(v8), abs(v9)
    v_cmp_gt_f32 s[54:55], s56, v40
    v_cvt_pk_f16_f32 v8, v8, v9
    v_max3_f32 v44, abs(v10), abs(v11), v44
    v_cvt_pk_f16_f32 v9, v10, v11
    v_cmp_gt_f32 vcc, s52, v44
    s_and_b64 s[54:55], s[54:55], exec
    s_bcnt1_i32_b64 s53, s[54:55]
    s_add_u32 s57, s57, s53
    s_and_b64 vcc, vcc, exec
    s_bcnt1_i32_b64 s53, vcc
    s_add_u32 s51, s51, s53
    buffer_store_dwordx2 v[8:9], v3, s[12:15], s16 offen sc0 sc1
    s_add_u32 s16, s16, 8192
    s_waitcnt lgkmcnt(4)
    v_lshrrev_b32 v40, 26, v12
    v_and_b32 v12, 0x3ffffff, v12
    v_mul_u32_u24 v40, 49, v40
    v_and_b32 v40, 63, v40
    v_mad_u64_u32 v[42:43], vcc, v40, s28, 0
    v_lshlrev_b32 v44, 19, v40
    v_add_u32 v5, v5, v40
    v_sub_u32 v12, v12, v44
    v_mul_u32_u24 v44, 17, v40
    v_sub_u32 v13, v13, v42
    v_lshrrev_b32 v44, 6, v44
    v_sub_u32 v13, v13, v44
    v_add_u32 v43, v43, v42
    v_sub_co_u32 v14, vcc, v14, v42
    v_cvt_f32_i32 v12, v12
    v_cvt_f32_i32 v13, v13
    v_subb_co_u32 v15, vcc, v15, v43, vcc
    v_ashrrev_i32 v44, 31, v14
    v_cvt_f32_i32 v14, v14
    v_sub_u32 v15, v15, v44
    v_min3_f32 v40, abs(v12), abs(v13), abs(v14)
    v_cvt_f32_i32 v15, v15
    v_pk_mul_f32 v[12:13], v[12:13], s[36:37]
    v_min_f32 v40, abs(v15), v40
    v_pk_mul_f32 v[14:15], v[14:15], s[38:39]
    v_max_f32 v44, abs(v12), abs(v13)
    v_cmp_gt_f32 s[54:55], s56, v40
    v_cvt_pk_f16_f32 v12, v12, v13
    v_max3_f32 v44, abs(v14), abs(v15), v44
    v_cvt_pk_f16_f32 v13, v14, v15
    v_cmp_gt_f32 vcc, s52, v44
    s_and_b64 s[54:55], s[54:55], exec
    s_bcnt1_i32_b64 s53, s[54:55]
    s_add_u32 s57, s57, s53
    s_and_b64 vcc, vcc, exec
    s_bcnt1_i32_b64 s53, vcc
    s_add_u32 s51, s51, s53
    buffer_store_dwordx2 v[12:13], v3, s[12:15], s16 offen sc0 sc1
    s_add_u32 s16, s16, 8192
    s_waitcnt lgkmcnt(3)
    v_lshrrev_b32 v40, 26, v16
    v_and_b32 v16, 0x3ffffff, v16
    v_mul_u32_u24 v40, 49, v40
    v_and_b32 v40, 63, v40
    v_mad_u64_u32 v[42:43], vcc, v40, s28, 0
    v_lshlrev_b32 v44, 19, v40
    v_add_u32 v5, v5, v40
    v_sub_u32 v16, v16, v44
    v_mul_u32_u24 v44, 17, v40
    v_sub_u32 v17, v17, v42
    v_lshrrev_b32 v44, 6, v44
    v_sub_u32 v17, v17, v44
    v_add_u32 v43, v43, v42
    v_sub_co_u32 v18, vcc, v18, v42
    v_cvt_f32_i32 v16, v16
    v_cvt_f32_i32 v17, v17
    v_subb_co_u32 v19, vcc, v19, v43, vcc
    v_ashrrev_i32 v44, 31, v18
    v_cvt_f32_i32 v18, v18
    v_sub_u32 v19, v19, v44
    v_min3_f32 v40, abs(v16), abs(v17), abs(v18)
    v_cvt_f32_i32 v19, v19
    v_pk_mul_f32 v[16:17], v[16:17], s[36:37]
    v_min_f32 v40, abs(v19), v40
    v_pk_mul_f32 v[18:19], v[18:19], s[38:39]
    v_max_f32 v44, abs(v16), abs(v17)
    v_cmp_gt_f32 s[54:55], s56, v40
    v_cvt_pk_f16_f32 v16, v16, v17
    v_max3_f32 v44, abs(v18), abs(v19), v44
    v_cvt_pk_f16_f32 v17, v18, v19
    v_cmp_gt_f32 vcc, s52, v44
    s_and_b64 s[54:55], s[54:55], exec
    s_bcnt1_i32_b64 s53, s[54:55]
    s_add_u32 s57, s57, s53
    s_and_b64 vcc, vcc, exec
    s_bcnt1_i32_b64 s53, vcc
    s_add_u32 s51, s51, s53
    buffer_store_dwordx2 v[16:17], v3, s[12:15], s16 offen sc0 sc1
    s_add_u32 s16, s16, 8192
    s_waitcnt lgkmcnt(2)
    v_lshrrev_b32 v40, 26, v20
    v_and_b32 v20, 0x3ffffff, v20
    v_mul_u32_u24 v40, 49, v40
    v_and_b32 v40, 63, v40
    v_mad_u64_u32 v[42:43], vcc, v40, s28, 0
    v_lshlrev_b32 v44, 19, v40
    v_add_u32 v5, v5, v40
    v_sub_u32 v20, v20, v44
    v_mul_u32_u24 v44, 17, v40
    v_sub_u32 v21, v21, v42
    v_lshrrev_b32 v44, 6, v44
    v_sub_u32 v21, v21, v44
    v_add_u32 v43, v43, v42
    v_sub_co_u32 v22, vcc, v22, v42
    v_cvt_f32_i32 v20, v20
    v_cvt_f32_i32 v21, v21
    v_subb_co_u32 v23, vcc, v23, v43, vcc
    v_ashrrev_i32 v44, 31, v22
    v_cvt_f32_i32 v22, v22
    v_sub_u32 v23, v23, v44
    v_min3_f32 v40, abs(v20), abs(v21), abs(v22)
    v_cvt_f32_i32 v23, v23
    v_pk_mul_f32 v[20:21], v[20:21], s[36:37]
    v_min_f32 v40, abs(v23), v40
    v_pk_mul_f32 v[22:23], v[22:23], s[38:39]
    v_max_f32 v44, abs(v20), abs(v21)
    v_cmp_gt_f32 s[54:55], s56, v40
    v_cvt_pk_f16_f32 v20, v20, v21
    v_max3_f32 v44, abs(v22), abs(v23), v44
    v_cvt_pk_f16_f32 v21, v22, v23
    v_cmp_gt_f32 vcc, s52, v44
    s_and_b64 s[54:55], s[54:55], exec
    s_bcnt1_i32_b64 s53, s[54:55]
    s_add_u32 s57, s57, s53
    s_and_b64 vcc, vcc, exec
    s_bcnt1_i32_b64 s53, vcc
    s_add_u32 s51, s51, s53
    buffer_store_dwordx2 v[20:21], v3, s[12:15], s16 offen sc0 sc1
    s_add_u32 s16, s16, 8192
    s_waitcnt lgkmcnt(1)
    v_lshrrev_b32 v40, 26, v24
    v_and_b32 v24, 0x3ffffff, v24
    v_mul_u32_u24 v40, 49, v40
    v_and_b32 v40, 63, v40
    v_mad_u64_u32 v[42:43], vcc, v40, s28, 0
    v_lshlrev_b32 v44, 19, v40
    v_add_u32 v5, v5, v40
    v_sub_u32 v24, v24, v44
    v_mul_u32_u24 v44, 17, v40
    v_sub_u32 v25, v25, v42
    v_lshrrev_b32 v44, 6, v44
    v_sub_u32 v25, v25, v44
    v_add_u32 v43, v43, v42
    v_sub_co_u32 v26, vcc, v26, v42
    v_cvt_f32_i32 v24, v24
    v_cvt_f32_i32 v25, v25
    v_subb_co_u32 v27, vcc, v27, v43, vcc
    v_ashrrev_i32 v44, 31, v26
    v_cvt_f32_i32 v26, v26
    v_sub_u32 v27, v27, v44
    v_min3_f32 v40, abs(v24), abs(v25), abs(v26)
    v_cvt_f32_i32 v27, v27
    v_pk_mul_f32 v[24:25], v[24:25], s[36:37]
    v_min_f32 v40, abs(v27), v40
    v_pk_mul_f32 v[26:27], v[26:27], s[38:39]
    v_max_f32 v44, abs(v24), abs(v25)
    v_cmp_gt_f32 s[54:55], s56, v40
    v_cvt_pk_f16_f32 v24, v24, v25
    v_max3_f32 v44, abs(v26), abs(v27), v44
    v_cvt_pk_f16_f32 v25, v26, v27
    v_cmp_gt_f32 vcc, s52, v44
    s_and_b64 s[54:55], s[54:55], exec
    s_bcnt1_i32_b64 s53, s[54:55]
    s_add_u32 s57, s57, s53
    s_and_b64 vcc, vcc, exec
    s_bcnt1_i32_b64 s53, vcc
    s_add_u32 s51, s51, s53
    buffer_store_dwordx2 v[24:25], v3, s[12:15], s16 offen sc0 sc1
    s_add_u32 s16, s16, 8192
    s_waitcnt lgkmcnt(0)
    v_lshrrev_b32 v40, 26, v28
    v_and_b32 v28, 0x3ffffff, v28
    v_mul_u32_u24 v40, 49, v40
    v_and_b32 v40, 63, v40
    v_mad_u64_u32 v[42:43], vcc, v40, s28, 0
    v_lshlrev_b32 v44, 19, v40
    v_add_u32 v5, v5, v40
    v_sub_u32 v28, v28, v44
    v_mul_u32_u24 v44, 17, v40
    v_sub_u32 v29, v29, v42
    v_lshrrev_b32 v44, 6, v44
    v_sub_u32 v29, v29, v44
    v_add_u32 v43, v43, v42
    v_sub_co_u32 v30, vcc, v30, v42
    v_cvt_f32_i32 v28, v28
    v_cvt_f32_i32 v29, v29
    v_subb_co_u32 v31, vcc, v31, v43, vcc
    v_ashrrev_i32 v44, 31, v30
    v_cvt_f32_i32 v30, v30
    v_sub_u32 v31, v31, v44
    v_min3_f32 v40, abs(v28), abs(v29), abs(v30)
    v_cvt_f32_i32 v31, v31
    v_pk_mul_f32 v[28:29], v[28:29], s[36:37]
    v_min_f32 v40, abs(v31), v40
    v_pk_mul_f32 v[30:31], v[30:31], s[38:39]
    v_max_f32 v44, abs(v28), abs(v29)
    v_cmp_gt_f32 s[54:55], s56, v40
    v_cvt_pk_f16_f32 v28, v28, v29
    v_max3_f32 v44, abs(v30), abs(v31), v44
    v_cvt_pk_f16_f32 v29, v30, v31
    v_cmp_gt_f32 vcc, s52, v44
    s_and_b64 s[54:55], s[54:55], exec
    s_bcnt1_i32_b64 s53, s[54:55]
    s_add_u32 s57, s57, s53
    s_and_b64 vcc, vcc, exec
    s_bcnt1_i32_b64 s53, vcc
    s_add_u32 s51, s51, s53
    buffer_store_dwordx2 v[28:29], v3, s[12:15], s16 offen sc0 sc1
    s_add_u32 s16, s16, 8192
    s_waitcnt lgkmcnt(0)
    s_mov_b64 exec, s[24:25]
    v_lshrrev_b32 v40, 26, v32
    v_and_b32 v32, 0x3ffffff, v32
    v_mul_u32_u24 v40, 49, v40
    v_and_b32 v40, 63, v40
    v_mad_u64_u32 v[42:43], vcc, v40, s28, 0
    v_lshlrev_b32 v44, 19, v40
    v_add_u32 v5, v5, v40
    v_sub_u32 v32, v32, v44
    v_mul_u32_u24 v44, 17, v40
    v_sub_u32 v33, v33, v42
    v_lshrrev_b32 v44, 6, v44
    v_sub_u32 v33, v33, v44
    v_add_u32 v43, v43, v42
    v_sub_co_u32 v34, vcc, v34, v42
    v_cvt_f32_i32 v32, v32
    v_cvt_f32_i32 v33, v33
    v_subb_co_u32 v35, vcc, v35, v43, vcc
    v_ashrrev_i32 v44, 31, v34
    v_cvt_f32_i32 v34, v34
    v_sub_u32 v35, v35, v44
    v_min3_f32 v40, abs(v32), abs(v33), abs(v34)
    v_cvt_f32_i32 v35, v35
    v_pk_mul_f32 v[32:33], v[32:33], s[36:37]
    v_min_f32 v40, abs(v35), v40
    v_pk_mul_f32 v[34:35], v[34:35], s[38:39]
    v_max_f32 v44, abs(v32), abs(v33)
    v_cmp_gt_f32 s[54:55], s56, v40
    v_cvt_pk_f16_f32 v32, v32, v33
    v_max3_f32 v44, abs(v34), abs(v35), v44
    v_cvt_pk_f16_f32 v33, v34, v35
    v_cmp_gt_f32 vcc, s52, v44
    s_and_b64 s[54:55], s[54:55], exec
    s_bcnt1_i32_b64 s53, s[54:55]
    s_add_u32 s57, s57, s53
    s_and_b64 vcc, vcc, exec
    s_bcnt1_i32_b64 s53, vcc
    s_add_u32 s51, s51, s53
    buffer_store_dwordx2 v[32:33], v3, s[12:15], s16 offen sc0 sc1
    s_add_u32 s16, s16, 8192
    s_mov_b64 exec, -1
    v_cmp_ne_u32 s[54:55], 0, v125
    s_nop 1
    v_add_u32_dpp v5, v5, v5 row_shr:1 row_mask:0xf bank_mask:0xf bound_ctrl:0
    s_nop 1
    v_add_u32_dpp v5, v5, v5 row_shr:2 row_mask:0xf bank_mask:0xf bound_ctrl:0
    s_nop 1
    v_add_u32_dpp v5, v5, v5 row_shr:4 row_mask:0xf bank_mask:0xf bound_ctrl:0
    s_nop 1
    v_add_u32_dpp v5, v5, v5 row_shr:8 row_mask:0xf bank_mask:0xf bound_ctrl:0
    s_nop 1
    v_add_u32_dpp v5, v5, v5 row_bcast:15 row_mask:0xa bank_mask:0xf
    s_nop 1
    v_add_u32_dpp v5, v5, v5 row_bcast:31 row_mask:0xc bank_mask:0xf
    s_nop 1
    v_readlane_b32 s42, v5, 63
    s_nop 3
    s_lshl_b32 s42, s42, 2
    s_add_u32 s42, s42, s32
    v_mov_b32 v6, s42
    s_cmp_lg_u64 s[54:55], 0
    s_cselect_b32 s53, 256, 0
    s_add_u32 s51, s51, s53
    s_lshl_b32 s57, s57, 16
    s_or_b32 s51, s51, s57
    v_mov_b32 v7, s51
    s_mov_b64 exec, 1
    ds_add_u32 v126, v6
    ds_add_u32 v126, v7 offset:4
    s_mov_b64 exec, -1
    s_waitcnt lgkmcnt(0)
    s_barrier
    ds_read_b64 v[6:7], v126
    s_waitcnt lgkmcnt(0)
    v_readfirstlane_b32 s42, v6
    v_readfirstlane_b32 s43, v7
    s_nop 3
    s_cmp_gt_u32 s43, 0x61b0000
    s_cselect_b32 s42, 1, s42
    s_and_b32 s43, s43, 0xffff
    s_cmp_gt_u32 s43, 195
    s_cselect_b32 s42, 1, s42
    s_cmp_eq_u32 s42, 0
    s_cbranch_scc1 Q_FIN
    s_waitcnt vmcnt(0)
    v_mov_b32 v6, 0x80000000
    v_mov_b32 v5, 0
    v_cmp_eq_u32 vcc, 0, v0
    s_mov_b64 exec, vcc
    buffer_store_dword v6, v5, s[12:15], s41 offen
    s_mov_b64 exec, -1
    v_lshrrev_b32 v8, 1, v0
    v_lshrrev_b32 v9, 2, v0
    v_mul_u32_u24 v9, 16448, v9
    v_and_b32 v39, 1, v8
    v_lshl_add_u32 v9, v39, 5, v9
    s_mov_b32 s16, 133376
    v_mul_lo_u32 v8, v8, s16
    v_and_b32 v10, 1, v0
    v_mov_b32 v12, 0
    v_mov_b32 v13, 0
    v_mov_b32 v14, 0
    v_mov_b32 v15, 0
    v_add_u32 v11, 65536, v2
    s_mov_b32 s48, 0
Q_FH:
    s_barrier
    ds_write_b128 v2, v[12:15] offset:0
    ds_write_b128 v2, v[12:15] offset:16384
    ds_write_b128 v2, v[12:15] offset:32768
    ds_write_b128 v2, v[12:15] offset:49152
    ds_write_b128 v11, v[12:15] offset:0
    ds_write_b128 v11, v[12:15] offset:16384
    s_mov_b64 exec, s[24:25]
    ds_write_b128 v11, v[12:15] offset:32768
    s_mov_b64 exec, -1
    s_waitcnt lgkmcnt(0)
    s_barrier
    s_lshl_b32 s49, s3, 6
    s_add_u32 s49, s49, 0x4400000
    s_lshr_b32 s50, s3, 6
    s_mul_i32 s50, s50, 800016
    s_mov_b32 s51, 0
Q_FR:
    buffer_load_ushort v16, v9, s[12:15], s49 offen offset:66
    buffer_load_ushort v17, v9, s[12:15], s49 offen offset:68
    s_waitcnt vmcnt(0)
    s_bitcmp0_b32 s3, 0
    s_cbranch_scc1 Q_FA
    v_sub_u32 v18, 33340, v16
    v_sub_u32 v16, 33340, v17
    v_mov_b32 v17, v18
Q_FA:
    v_add_u32 v16, v16, v10
Q_FI:
    v_cmp_lt_u32 vcc, v16, v17
    s_and_b64 exec, exec, vcc
    s_cbranch_execz Q_FRN
    s_mov_b64 s[52:53], exec
    v_and_b32 v18, 3, v16
    v_lshl_add_u32 v19, v16, 2, v8
    v_or_b32 v20, 3, v16
    v_lshl_add_u32 v20, v20, 2, v8
    v_add_u32 v20, v20, v18
    buffer_load_dword v21, v19, s[12:15], 0 offen
    buffer_load_ubyte v22, v20, s[12:15], 0 offen
    s_waitcnt vmcnt(0)
    v_bfe_u32 v23, v21, 13, 13
    v_subrev_u32 v23, s48, v23
    s_movk_i32 s16, 3125
    v_cmp_gt_u32 vcc, s16, v23
    v_cmp_ne_u32 s[54:55], 3, v18
    s_and_b64 vcc, vcc, s[54:55]
    v_bfe_u32 v24, v21, 0, 13
    v_lshlrev_b32 v24, 3, v24
    s_and_b64 exec, exec, vcc
    s_cbranch_execz Q_FIN2
    buffer_load_dwordx2 v[26:27], v24, s[8:11], s50 offen
    v_lshlrev_b32 v22, 2, v22
    v_lshrrev_b32 v25, 16, v21
    v_and_b32 v25, 0xfc00, v25
    v_or_b32 v25, v25, v22
    v_cvt_f32_f16 v25, v25
    v_cvt_f64_f32 v[28:29], v25
    v_lshlrev_b32 v23, 3, v23
    v_add_u32 v38, 50000, v23
    s_waitcnt vmcnt(0)
    v_lshlrev_b32 v30, 16, v26
    v_and_b32 v32, s30, v26
    v_lshlrev_b32 v34, 16, v27
    v_and_b32 v36, s30, v27
    v_cvt_f64_f32 v[30:31], v30
    v_mul_f64 v[30:31], v[30:31], v[28:29]
    ds_add_f64 v23, v[30:31] offset:0
    v_cvt_f64_f32 v[32:33], v32
    v_mul_f64 v[32:33], v[32:33], v[28:29]
    ds_add_f64 v23, v[32:33] offset:25000
    v_cvt_f64_f32 v[34:35], v34
    v_mul_f64 v[34:35], v[34:35], v[28:29]
    ds_add_f64 v38, v[34:35] offset:0
    v_cvt_f64_f32 v[36:37], v36
    v_mul_f64 v[36:37], v[36:37], v[28:29]
    ds_add_f64 v38, v[36:37] offset:25000
Q_FIN2:
    s_mov_b64 exec, s[52:53]
    v_add_u32 v16, 2, v16
    s_branch Q_FI
Q_FRN:
    s_mov_b64 exec, -1
    s_add_u32 s49, s49, 2
    s_add_u32 s50, s50, 57144
    s_add_u32 s51, s51, 1
    s_cmp_lt_u32 s51, 14
    s_cbranch_scc1 Q_FR
    s_waitcnt lgkmcnt(0)
    s_barrier
    s_lshr_b32 s16, s3, 6
    s_mul_i32 s16, s16, 3200000
    s_and_b32 s17, s3, 63
    s_mul_i32 s17, s17, 50000
    s_add_u32 s16, s16, s17
    s_add_u32 s16, s16, 0x5000000
    s_lshl_b32 s17, s48, 3
    s_add_u32 s16, s16, s17
    s_sub_u32 s52, s16, 0x5000000
    s_lshl_b32 s52, s52, 1
    s_add_u32 s52, s52, 0x7000000
    v_mov_b32 v16, v3
Q_FC:
    s_movk_i32 s17, 25000
    v_cmp_gt_u32 vcc, s17, v16
    s_and_b64 exec, exec, vcc
    s_cbranch_execz Q_FCD
    v_add_u32 v17, 50000, v16
    ds_read_b64 v[18:19], v16 offset:0
    ds_read_b64 v[20:21], v16 offset:25000
    ds_read_b64 v[22:23], v17 offset:0
    ds_read_b64 v[24:25], v17 offset:25000
    s_waitcnt lgkmcnt(0)
    v_cvt_f32_f64 v30, v[18:19]
    v_cvt_f32_f64 v31, v[20:21]
    v_cvt_f32_f64 v32, v[22:23]
    v_cvt_f32_f64 v33, v[24:25]
    v_lshlrev_b32 v17, 1, v16
    buffer_store_dwordx4 v[30:33], v17, s[12:15], s52 offen
    buffer_store_dwordx2 v[12:13], v16, s[12:15], s16 offen
    v_add_u32 v16, 8192, v16
    s_branch Q_FC
Q_FCD:
    s_mov_b64 exec, -1
    s_add_u32 s48, s48, 3125
    s_cmp_lt_u32 s48, 6250
    s_cbranch_scc1 Q_FH
Q_FIN:
Q_END:
    s_endpgm
.globl fin_kernel
.p2align 8
.type fin_kernel,@function
fin_kernel:
    s_cmp_ge_u32 s2, 1563
    s_cbranch_scc1 F_END
    s_load_dwordx2 s[4:5], s[0:1], 0
    s_load_dwordx2 s[6:7], s[0:1], 104
    s_load_dwordx2 s[8:9], s[0:1], 24
    s_load_dwordx2 s[10:11], s[0:1], 88
    s_load_dwordx2 s[28:29], s[0:1], 40
    s_load_dwordx8 s[64:71], s[0:1], 56
    s_mul_i32 s3, s2, 256
    v_add_u32 v3, s3, v0
    v_lshlrev_b32 v5, 1, v3
    v_min_u32 v4, 399999, v3
    v_lshlrev_b32 v2, 3, v4
    v_mul_hi_u32_u24 v4, 0xa7c5b, v4
    v_lshlrev_b32 v4, 4, v4
    v_lshlrev_b32 v3, 3, v3
    s_waitcnt lgkmcnt(0)
    s_mov_b32 s20, s8
    s_and_b32 s21, s9, 0xffff
    s_mov_b32 s22, 0xc3500
    s_mov_b32 s23, 0x00020000
    buffer_load_ushort v5, v5, s[20:23], 0 offen
    s_load_dwordx4 s[28:31], s[28:29], 0
    s_load_dwordx16 s[32:47], s[64:65], 0
    s_load_dwordx16 s[48:63], s[66:67], 0
    s_load_dwordx8 s[72:79], s[70:71], 0
    s_load_dwordx8 s[64:71], s[68:69], 0
    s_mov_b32 s16, s6
    s_and_b32 s17, s7, 0xffff
    s_mov_b32 s18, 0x10000000
    s_mov_b32 s19, 0x00020000
    s_mov_b32 s12, s4
    s_and_b32 s13, s5, 0xffff
    s_mov_b32 s14, 0x30d400
    s_mov_b32 s15, 0x00020000
    s_mov_b32 s24, s10
    s_and_b32 s25, s11, 0xffff
    s_mov_b32 s26, 0x30d400
    s_mov_b32 s27, 0x00020000
    s_mov_b32 s4, 0x4c03000
    buffer_load_dwordx4 v[8:11], v4, s[16:19], s4 offen
    s_mov_b32 s4, 0x5000000
    buffer_load_dwordx2 v[34:35], v2, s[16:19], s4 offen
    s_mov_b32 s4, 0x530d400
    buffer_load_dwordx2 v[36:37], v2, s[16:19], s4 offen
    s_mov_b32 s4, 0x561a800
    buffer_load_dwordx2 v[38:39], v2, s[16:19], s4 offen
    s_mov_b32 s4, 0x5927c00
    buffer_load_dwordx2 v[40:41], v2, s[16:19], s4 offen
    buffer_load_dwordx2 v[6:7], v3, s[12:15], 0 offen
    s_mov_b32 s5, 0xffff0000
    s_mov_b32 s8, 0xc1200000
    s_mov_b32 s9, 0x3fb8aa3b
    s_waitcnt vmcnt(6) lgkmcnt(0)
    v_lshlrev_b32 v5, 16, v5
    s_lshl_b32 s6, s28, 16
    s_and_b32 s7, s28, 0xffff0000
    v_subrev_f32 v16, s6, v5
    v_subrev_f32 v17, s7, v5
    v_cvt_pk_bf16_f32 v4, v16, v17
    v_lshlrev_b32 v16, 16, v4
    v_and_b32 v17, s5, v4
    v_mul_f32 v16, v16, v16
    v_mul_f32 v17, v17, v17
    v_cvt_pk_bf16_f32 v4, v16, v17
    v_lshlrev_b32 v16, 16, v4
    v_and_b32 v17, s5, v4
    v_mul_f32 v16, s8, v16
    v_mul_f32 v17, s8, v17
    v_cvt_pk_bf16_f32 v4, v16, v17
    v_lshlrev_b32 v16, 16, v4
    v_and_b32 v17, s5, v4
    v_mul_f32 v16, s9, v16
    v_mul_f32 v17, s9, v17
    v_exp_f32 v16, v16
    v_exp_f32 v17, v17
    s_nop 0
    v_cvt_pk_bf16_f32 v20, v16, v17
    s_lshl_b32 s6, s29, 16
    s_and_b32 s7, s29, 0xffff0000
    v_subrev_f32 v16, s6, v5
    v_subrev_f32 v17, s7, v5
    v_cvt_pk_bf16_f32 v4, v16, v17
    v_lshlrev_b32 v16, 16, v4
    v_and_b32 v17, s5, v4
    v_mul_f32 v16, v16, v16
    v_mul_f32 v17, v17, v17
    v_cvt_pk_bf16_f32 v4, v16, v17
    v_lshlrev_b32 v16, 16, v4
    v_and_b32 v17, s5, v4
    v_mul_f32 v16, s8, v16
    v_mul_f32 v17, s8, v17
    v_cvt_pk_bf16_f32 v4, v16, v17
    v_lshlrev_b32 v16, 16, v4
    v_and_b32 v17, s5, v4
    v_mul_f32 v16, s9, v16
    v_mul_f32 v17, s9, v17
    v_exp_f32 v16, v16
    v_exp_f32 v17, v17
    s_nop 0
    v_cvt_pk_bf16_f32 v21, v16, v17
    s_lshl_b32 s6, s30, 16
    s_and_b32 s7, s30, 0xffff0000
    v_subrev_f32 v16, s6, v5
    v_subrev_f32 v17, s7, v5
    v_cvt_pk_bf16_f32 v4, v16, v17
    v_lshlrev_b32 v16, 16, v4
    v_and_b32 v17, s5, v4
    v_mul_f32 v16, v16, v16
    v_mul_f32 v17, v17, v17
    v_cvt_pk_bf16_f32 v4, v16, v17
    v_lshlrev_b32 v16, 16, v4
    v_and_b32 v17, s5, v4
    v_mul_f32 v16, s8, v16
    v_mul_f32 v17, s8, v17
    v_cvt_pk_bf16_f32 v4, v16, v17
    v_lshlrev_b32 v16, 16, v4
    v_and_b32 v17, s5, v4
    v_mul_f32 v16, s9, v16
    v_mul_f32 v17, s9, v17
    v_exp_f32 v16, v16
    v_exp_f32 v17, v17
    s_nop 0
    v_cvt_pk_bf16_f32 v22, v16, v17
    s_lshl_b32 s6, s31, 16
    s_and_b32 s7, s31, 0xffff0000
    v_subrev_f32 v16, s6, v5
    v_subrev_f32 v17, s7, v5
    v_cvt_pk_bf16_f32 v4, v16, v17
    v_lshlrev_b32 v16, 16, v4
    v_and_b32 v17, s5, v4
    v_mul_f32 v16, v16, v16
    v_mul_f32 v17, v17, v17
    v_cvt_pk_bf16_f32 v4, v16, v17
    v_lshlrev_b32 v16, 16, v4
    v_and_b32 v17, s5, v4
    v_mul_f32 v16, s8, v16
    v_mul_f32 v17, s8, v17
    v_cvt_pk_bf16_f32 v4, v16, v17
    v_lshlrev_b32 v16, 16, v4
    v_and_b32 v17, s5, v4
    v_mul_f32 v16, s9, v16
    v_mul_f32 v17, s9, v17
    v_exp_f32 v16, v16
    v_exp_f32 v17, v17
    s_nop 0
    v_cvt_pk_bf16_f32 v23, v16, v17
    s_pack_ll_b32_b16 s6, s48, s50
    v_dot2_f32_bf16 v24, v20, s6, 0
    s_pack_hh_b32_b16 s7, s48, s50
    v_dot2_f32_bf16 v25, v20, s7, 0
    s_pack_ll_b32_b16 s6, s49, s51
    v_dot2_f32_bf16 v26, v20, s6, 0
    s_pack_hh_b32_b16 s7, s49, s51
    v_dot2_f32_bf16 v27, v20, s7, 0
    s_pack_ll_b32_b16 s6, s32, s34
    v_dot2_f32_bf16 v28, v20, s6, 0
    s_pack_hh_b32_b16 s7, s32, s34
    v_dot2_f32_bf16 v29, v20, s7, 0
    s_pack_ll_b32_b16 s6, s33, s35
    v_dot2_f32_bf16 v30, v20, s6, 0
    s_pack_hh_b32_b16 s7, s33, s35
    v_dot2_f32_bf16 v31, v20, s7, 0
    s_pack_ll_b32_b16 s6, s52, s54
    v_dot2_f32_bf16 v24, v21, s6, v24
    s_pack_hh_b32_b16 s7, s52, s54
    v_dot2_f32_bf16 v25, v21, s7, v25
    s_pack_ll_b32_b16 s6, s53, s55
    v_dot2_f32_bf16 v26, v21, s6, v26
    s_pack_hh_b32_b16 s7, s53, s55
    v_dot2_f32_bf16 v27, v21, s7, v27
    s_pack_ll_b32_b16 s6, s36, s38
    v_dot2_f32_bf16 v28, v21, s6, v28
    s_pack_hh_b32_b16 s7, s36, s38
    v_dot2_f32_bf16 v29, v21, s7, v29
    s_pack_ll_b32_b16 s6, s37, s39
    v_dot2_f32_bf16 v30, v21, s6, v30
    s_pack_hh_b32_b16 s7, s37, s39
    v_dot2_f32_bf16 v31, v21, s7, v31
    s_pack_ll_b32_b16 s6, s56, s58
    v_dot2_f32_bf16 v24, v22, s6, v24
    s_pack_hh_b32_b16 s7, s56, s58
    v_dot2_f32_bf16 v25, v22, s7, v25
    s_pack_ll_b32_b16 s6, s57, s59
    v_dot2_f32_bf16 v26, v22, s6, v26
    s_pack_hh_b32_b16 s7, s57, s59
    v_dot2_f32_bf16 v27, v22, s7, v27
    s_pack_ll_b32_b16 s6, s40, s42
    v_dot2_f32_bf16 v28, v22, s6, v28
    s_pack_hh_b32_b16 s7, s40, s42
    v_dot2_f32_bf16 v29, v22, s7, v29
    s_pack_ll_b32_b16 s6, s41, s43
    v_dot2_f32_bf16 v30, v22, s6, v30
    s_pack_hh_b32_b16 s7, s41, s43
    v_dot2_f32_bf16 v31, v22, s7, v31
    s_pack_ll_b32_b16 s6, s60, s62
    v_dot2_f32_bf16 v24, v23, s6, v24
    s_pack_hh_b32_b16 s7, s60, s62
    v_dot2_f32_bf16 v25, v23, s7, v25
    s_pack_ll_b32_b16 s6, s61, s63
    v_dot2_f32_bf16 v26, v23, s6, v26
    s_pack_hh_b32_b16 s7, s61, s63
    v_dot2_f32_bf16 v27, v23, s7, v27
    s_pack_ll_b32_b16 s6, s44, s46
    v_dot2_f32_bf16 v28, v23, s6, v28
    s_pack_hh_b32_b16 s7, s44, s46
    v_dot2_f32_bf16 v29, v23, s7, v29
    s_pack_ll_b32_b16 s6, s45, s47
    v_dot2_f32_bf16 v30, v23, s6, v30
    s_pack_hh_b32_b16 s7, s45, s47
    v_dot2_f32_bf16 v31, v23, s7, v31
    s_nop 2
    v_cvt_pk_bf16_f32 v4, v28, v29
    v_lshlrev_b32 v28, 16, v4
    v_and_b32 v29, s5, v4
    v_cvt_pk_bf16_f32 v4, v30, v31
    v_lshlrev_b32 v30, 16, v4
    v_and_b32 v31, s5, v4
    s_waitcnt vmcnt(0)
    v_fma_mix_f32 v16, v34, v8, 0 op_sel:[0,0,0] op_sel_hi:[1,0,0]
    v_fma_mix_f32 v17, v34, v8, 0 op_sel:[1,0,0] op_sel_hi:[1,0,0]
    v_fma_mix_f32 v18, v35, v8, 0 op_sel:[0,0,0] op_sel_hi:[1,0,0]
    v_fma_mix_f32 v19, v35, v8, 0 op_sel:[1,0,0] op_sel_hi:[1,0,0]
    v_fma_mix_f32 v16, v36, v9, v16 op_sel:[0,0,0] op_sel_hi:[1,0,0]
    v_fma_mix_f32 v17, v36, v9, v17 op_sel:[1,0,0] op_sel_hi:[1,0,0]
    v_fma_mix_f32 v18, v37, v9, v18 op_sel:[0,0,0] op_sel_hi:[1,0,0]
    v_fma_mix_f32 v19, v37, v9, v19 op_sel:[1,0,0] op_sel_hi:[1,0,0]
    v_fma_mix_f32 v16, v38, v10, v16 op_sel:[0,0,0] op_sel_hi:[1,0,0]
    v_fma_mix_f32 v17, v38, v10, v17 op_sel:[1,0,0] op_sel_hi:[1,0,0]
    v_fma_mix_f32 v18, v39, v10, v18 op_sel:[0,0,0] op_sel_hi:[1,0,0]
    v_fma_mix_f32 v19, v39, v10, v19 op_sel:[1,0,0] op_sel_hi:[1,0,0]
    v_fma_mix_f32 v16, v40, v11, v16 op_sel:[0,0,0] op_sel_hi:[1,0,0]
    v_fma_mix_f32 v17, v40, v11, v17 op_sel:[1,0,0] op_sel_hi:[1,0,0]
    v_fma_mix_f32 v18, v41, v11, v18 op_sel:[0,0,0] op_sel_hi:[1,0,0]
    v_fma_mix_f32 v19, v41, v11, v19 op_sel:[1,0,0] op_sel_hi:[1,0,0]
    v_or_b32 v4, v8, v9
    v_or3_b32 v4, v10, v11, v4
    v_cmp_gt_i32 vcc, 0, v4
    s_cbranch_vccnz F_P32
F_BACK:
    s_lshl_b32 s6, s64, 16
    v_mul_f32 v12, s6, v16
    s_and_b32 s7, s64, 0xffff0000
    v_mul_f32 v13, s7, v16
    s_lshl_b32 s6, s65, 16
    v_mul_f32 v14, s6, v16
    s_and_b32 s7, s65, 0xffff0000
    v_mul_f32 v15, s7, v16
    s_lshl_b32 s6, s66, 16
    v_fmac_f32 v12, s6, v17
    s_and_b32 s7, s66, 0xffff0000
    v_fmac_f32 v13, s7, v17
    s_lshl_b32 s6, s67, 16
    v_fmac_f32 v14, s6, v17
    s_and_b32 s7, s67, 0xffff0000
    v_fmac_f32 v15, s7, v17
    s_lshl_b32 s6, s68, 16
    v_fmac_f32 v12, s6, v18
    s_and_b32 s7, s68, 0xffff0000
    v_fmac_f32 v13, s7, v18
    s_lshl_b32 s6, s69, 16
    v_fmac_f32 v14, s6, v18
    s_and_b32 s7, s69, 0xffff0000
    v_fmac_f32 v15, s7, v18
    s_lshl_b32 s6, s70, 16
    v_fmac_f32 v12, s6, v19
    s_and_b32 s7, s70, 0xffff0000
    v_fmac_f32 v13, s7, v19
    s_lshl_b32 s6, s71, 16
    v_fmac_f32 v14, s6, v19
    s_and_b32 s7, s71, 0xffff0000
    v_fmac_f32 v15, s7, v19
    v_mul_f32 v12, v12, v24
    v_mul_f32 v13, v13, v25
    v_mul_f32 v14, v14, v26
    v_mul_f32 v15, v15, v27
    v_cvt_pk_bf16_f32 v20, v12, v13
    v_cvt_pk_bf16_f32 v21, v14, v15
    s_pack_ll_b32_b16 s6, s72, s74
    v_dot2_f32_bf16 v24, v20, s6, 0
    s_pack_hh_b32_b16 s7, s72, s74
    v_dot2_f32_bf16 v25, v20, s7, 0
    s_pack_ll_b32_b16 s6, s73, s75
    v_dot2_f32_bf16 v26, v20, s6, 0
    s_pack_hh_b32_b16 s7, s73, s75
    v_dot2_f32_bf16 v27, v20, s7, 0
    s_pack_ll_b32_b16 s6, s76, s78
    v_dot2_f32_bf16 v24, v21, s6, v24
    s_pack_hh_b32_b16 s7, s76, s78
    v_dot2_f32_bf16 v25, v21, s7, v25
    s_pack_ll_b32_b16 s6, s77, s79
    v_dot2_f32_bf16 v26, v21, s6, v26
    s_pack_hh_b32_b16 s7, s77, s79
    v_dot2_f32_bf16 v27, v21, s7, v27
    v_lshlrev_b32 v12, 16, v6
    v_and_b32 v13, s5, v6
    v_lshlrev_b32 v14, 16, v7
    v_and_b32 v15, s5, v7
    s_nop 0
    v_cvt_pk_bf16_f32 v4, v24, v25
    v_lshlrev_b32 v24, 16, v4
    v_and_b32 v25, s5, v4
    v_cvt_pk_bf16_f32 v4, v26, v27
    v_lshlrev_b32 v26, 16, v4
    v_and_b32 v27, s5, v4
    v_mul_f32 v24, v24, v28
    v_mul_f32 v25, v25, v29
    v_mul_f32 v26, v26, v30
    v_mul_f32 v27, v27, v31
    v_cvt_pk_bf16_f32 v4, v24, v25
    v_lshlrev_b32 v24, 16, v4
    v_and_b32 v25, s5, v4
    v_cvt_pk_bf16_f32 v4, v26, v27
    v_lshlrev_b32 v26, 16, v4
    v_and_b32 v27, s5, v4
    v_add_f32 v24, v24, v12
    v_add_f32 v25, v25, v13
    v_add_f32 v26, v26, v14
    v_add_f32 v27, v27, v15
    v_cvt_pk_bf16_f32 v32, v24, v25
    v_cvt_pk_bf16_f32 v33, v26, v27
    buffer_store_dwordx2 v[32:33], v3, s[24:27], 0 offen sc0 sc1
F_END:
    s_endpgm
F_P32:
    v_lshlrev_b32 v4, 1, v2
    v_cmp_gt_i32 vcc, 0, v8
    s_mov_b32 s4, 0x7000000
    s_mov_b64 exec, vcc
    buffer_load_dwordx4 v[34:37], v4, s[16:19], s4 offen
    s_waitcnt vmcnt(0)
    v_add_f32 v16, v16, v34
    v_add_f32 v17, v17, v35
    v_add_f32 v18, v18, v36
    v_add_f32 v19, v19, v37
    s_mov_b64 exec, -1
    v_cmp_gt_i32 vcc, 0, v9
    s_mov_b32 s4, 0x761a800
    s_mov_b64 exec, vcc
    buffer_load_dwordx4 v[34:37], v4, s[16:19], s4 offen
    s_waitcnt vmcnt(0)
    v_add_f32 v16, v16, v34
    v_add_f32 v17, v17, v35
    v_add_f32 v18, v18, v36
    v_add_f32 v19, v19, v37
    s_mov_b64 exec, -1
    v_cmp_gt_i32 vcc, 0, v10
    s_mov_b32 s4, 0x7c35000
    s_mov_b64 exec, vcc
    buffer_load_dwordx4 v[34:37], v4, s[16:19], s4 offen
    s_waitcnt vmcnt(0)
    v_add_f32 v16, v16, v34
    v_add_f32 v17, v17, v35
    v_add_f32 v18, v18, v36
    v_add_f32 v19, v19, v37
    s_mov_b64 exec, -1
    v_cmp_gt_i32 vcc, 0, v11
    s_mov_b32 s4, 0x824f800
    s_mov_b64 exec, vcc
    buffer_load_dwordx4 v[34:37], v4, s[16:19], s4 offen
    s_waitcnt vmcnt(0)
    v_add_f32 v16, v16, v34
    v_add_f32 v17, v17, v35
    v_add_f32 v18, v18, v36
    v_add_f32 v19, v19, v37
    s_mov_b64 exec, -1
    s_branch F_BACK
CODE_END:
.section .rodata,"a"
.p2align 6
.amdhsa_kernel part_kernel
  .amdhsa_next_free_vgpr 128
  .amdhsa_next_free_sgpr 102
  .amdhsa_accum_offset 128
  .amdhsa_group_segment_fixed_size 0
  .amdhsa_kernarg_size 112
  .amdhsa_user_sgpr_count 2
  .amdhsa_user_sgpr_kernarg_segment_ptr 1
  .amdhsa_system_sgpr_workgroup_id_x 1
  .amdhsa_float_denorm_mode_32 3
.end_amdhsa_kernel
.p2align 6
.amdhsa_kernel acc_kernel
  .amdhsa_next_free_vgpr 128
  .amdhsa_next_free_sgpr 102
  .amdhsa_accum_offset 128
  .amdhsa_group_segment_fixed_size 0
  .amdhsa_kernarg_size 112
  .amdhsa_user_sgpr_count 2
  .amdhsa_user_sgpr_kernarg_segment_ptr 1
  .amdhsa_system_sgpr_workgroup_id_x 1
  .amdhsa_float_denorm_mode_32 3
.end_amdhsa_kernel
.p2align 6
.amdhsa_kernel fin_kernel
  .amdhsa_next_free_vgpr 44
  .amdhsa_next_free_sgpr 80
  .amdhsa_accum_offset 44
  .amdhsa_group_segment_fixed_size 0
  .amdhsa_kernarg_size 112
  .amdhsa_user_sgpr_count 2
  .amdhsa_user_sgpr_kernarg_segment_ptr 1
  .amdhsa_system_sgpr_workgroup_id_x 1
  .amdhsa_float_denorm_mode_32 3
.end_amdhsa_kernel
```
